```python
import torch

def _softmax(x, axis=-1):
    return torch.softmax(x, dim=axis)
def _gelu(x):
    return torch.nn.functional.gelu(x, approximate="tanh")
def _silu(x):
    return torch.nn.functional.silu(x)
def _sigmoid(x):
    return torch.sigmoid(x)
def _layernorm(x, axis=-1, eps=1e-5):
    m = x.mean(dim=axis, keepdim=True)
    v = x.var(dim=axis, keepdim=True, unbiased=False)
    return (x - m) / torch.sqrt(v + eps)
def _scatter_add(tgt, idx, src, axis=0):
    return tgt.clone().index_add_(axis, idx, src)
def _segment_sum(src, seg, n):
    out = torch.zeros((n,) + src.shape[1:], dtype=src.dtype)
    return out.index_add_(0, seg, src)
def _pad(x, pw):
    flat = tuple(v for pair in reversed(pw) for v in pair)
    return torch.nn.functional.pad(x, flat)

kernel_name = 'parallel_sum__mha_block_cached__glu_gated_swiglu__decode'

def setup_inputs():

    _w = (lambda a: (lambda t: t.to(torch.bfloat16) if t.is_floating_point() else t)(torch.as_tensor(a)))
    def _A_setup():
        B, Sq, D = 2, 1, 512
        H, Sk, Dh = 32, 16384, 128
        return {
            "x": _w((lambda *s: torch.randn(*s, dtype=torch.bfloat16) * 0.05)(B, Sq, D)),
            "k_cache": _w((lambda *s: torch.randn(*s, dtype=torch.bfloat16) * 1.6)(B, H, Sk, Dh)),
            "v_cache": _w((lambda *s: torch.randn(*s, dtype=torch.bfloat16) * 0.8)(B, H, Sk, Dh)),
            "wq": _w((lambda *s: torch.randn(*s, dtype=torch.bfloat16) * 1.6)(D, H * Dh) * (D ** -0.5)),
            "wo": _w((lambda *s: torch.randn(*s, dtype=torch.bfloat16) * 0.8)(H * Dh, D) * ((H * Dh) ** -0.5)),
        }
    _A_in = _A_setup()

    def _B_setup():
        B, S, D, F = 2, 1, 512, 1792
        return {
            "x": _w((lambda *s: torch.randn(*s, dtype=torch.bfloat16) * 0.05)(B, S, D)),
            "w1": _w((lambda *s: torch.randn(*s, dtype=torch.bfloat16) * 0.4)(D, F) * (2.0 / D) ** 0.5),
            "w3": _w((lambda *s: torch.randn(*s, dtype=torch.bfloat16) * 0.4)(D, F) * (2.0 / D) ** 0.5),
            "w2": _w((lambda *s: torch.randn(*s, dtype=torch.bfloat16) * 0.4)(F, D) * (2.0 / F) ** 0.5),
        }
    _B_in = _B_setup()

    return {
        "A_x": _A_in["x"],
        "A_k_cache": _A_in["k_cache"],
        "A_v_cache": _A_in["v_cache"],
        "A_wq": _A_in["wq"],
        "A_wo": _A_in["wo"],
        "B_x": _B_in["x"],
        "B_w1": _B_in["w1"],
        "B_w3": _B_in["w3"],
        "B_w2": _B_in["w2"],
    }

def reference(A_x, A_k_cache, A_v_cache, A_wq, A_wo, B_x, B_w1, B_w3, B_w2):
    def _A_ref(x, k_cache, v_cache, wq, wo):
        B, Sq, D = x.shape
        H, Dh = 32, 128
        q = (lambda x, *d: x.permute(*d))((x @ wq).reshape(B, Sq, H, Dh), 0, 2, 1, 3)
        scores = torch.einsum("bhqd,bhkd->bhqk", q, k_cache) * (Dh ** -0.5)
        p = _softmax(scores, axis=-1)
        o = torch.einsum("bhqk,bhkd->bhqd", p, v_cache)
        return (lambda x, *d: x.permute(*d))(o, 0, 2, 1, 3).reshape(B, Sq, H * Dh) @ wo

    def _B_ref(x, w1, w3, w2):
        gate = torch.einsum("bsd,df->bsf", x, w1)
        up = torch.einsum("bsd,df->bsf", x, w3)
        h = _silu(gate) * up
        out = torch.einsum("bsf,fd->bsd", h, w2)
        return out

    x = A_x
    xn = _layernorm(x, axis=-1)
    return x + _A_ref(xn, A_k_cache, A_v_cache, A_wq, A_wo) + _B_ref(xn, B_w1, B_w3, B_w2)
```

```asm
; @launch grid=(256,1,1) block=(512,1,1) lds=162048
.amdgcn_target "amdgcn-amd-amdhsa--gfx950"
.text
.globl parallel_sum__mha_block_cached__glu_gated_swiglu__decode_kernel
.p2align 8
.type parallel_sum__mha_block_cached__glu_gated_swiglu__decode_kernel,@function
parallel_sum__mha_block_cached__glu_gated_swiglu__decode_kernel:
    s_cmp_ge_u32 s2, 256
    s_cbranch_scc1 L_end
    s_load_dwordx16 s[8:23], s[0:1], 0
    s_load_dwordx8 s[24:31], s[0:1], 64
    v_lshrrev_b32 v1, 6, v0
    v_and_b32 v0, 63, v0
    v_readfirstlane_b32 s3, v1
    s_bfe_u32 s34, s2, 0x20003
    s_and_b32 s32, s2, 3
    s_bfe_u32 s33, s2, 0x20005
    s_lshl_b32 s33, s33, 2
    s_or_b32 s32, s32, s33
    s_bfe_u32 s33, s2, 0x10002
    s_lshl_b32 s33, s33, 4
    s_or_b32 s32, s32, s33
    s_lshr_b32 s33, s2, 7
    s_lshl_b32 s35, s33, 5
    s_add_u32 s35, s35, s32
    v_and_b32 v2, 15, v0
    v_lshrrev_b32 v3, 4, v0
    s_cmp_ge_u32 s3, 4
    s_cbranch_scc1 L_helper
    v_lshrrev_b32 v12, 2, v2
    v_and_b32 v13, 3, v2
    v_lshlrev_b32 v12, 8, v12
    v_lshlrev_b32 v13, 4, v13
    v_lshlrev_b32 v14, 6, v3
    v_add3_u32 v4, v12, v13, v14
    s_lshl_b32 s68, s3, 13
    s_lshl_b32 s69, s35, 2
    s_add_u32 s69, s69, s34
    s_lshl_b32 s69, s69, 20
    v_add_u32 v4, s68, v4
    v_add_u32 v5, 0x1000, v4
    s_mov_b32 s38, 0x100000
    s_mov_b32 s39, 0x00020000
    s_mov_b32 s64, 0
    s_waitcnt lgkmcnt(0)
    s_add_u32 s36, s10, s69
    s_addc_u32 s37, s11, 0
    buffer_load_dwordx4 v[64:67], v4, s[36:39], s64 offen offset:0 nt
    buffer_load_dwordx4 v[68:71], v4, s[36:39], s64 offen offset:1024 nt
    buffer_load_dwordx4 v[72:75], v4, s[36:39], s64 offen offset:2048 nt
    buffer_load_dwordx4 v[76:79], v4, s[36:39], s64 offen offset:3072 nt
    buffer_load_dwordx4 v[80:83], v5, s[36:39], s64 offen offset:0 nt
    s_add_u32 s40, s12, s69
    s_addc_u32 s41, s13, 0
    s_mov_b32 s42, 0x100000
    s_mov_b32 s43, 0x00020000
    v_lshlrev_b32 v6, 4, v0
    v_add_u32 v6, s68, v6
    v_add_u32 v7, 0x1000, v6
    s_mul_i32 s54, s3, 32768
    s_add_u32 s54, s54, 30976
    s_mov_b32 s48, 0x22222222
    s_mov_b32 s49, 0x22222222
    s_mov_b32 s50, 0x44444444
    s_mov_b32 s51, 0x44444444
    s_mov_b32 s52, 0x88888888
    s_mov_b32 s53, 0x88888888
    s_mov_b32 s56, 0xf000f
    s_mov_b32 s57, 0xf000f
    s_mov_b32 s58, 0xf000f0
    s_mov_b32 s59, 0xf000f0
    s_mov_b32 s60, 0xf000f00
    s_mov_b32 s61, 0xf000f00
    s_mov_b32 s62, 0xf000f000
    s_mov_b32 s63, 0xf000f000
    s_waitcnt vmcnt(4)
    buffer_load_dwordx4 v[84:87], v5, s[36:39], s64 offen offset:1024 nt
    s_mul_i32 s68, s3, 4160
    v_mul_u32_u24 v9, 1040, v3
    v_add_u32 v9, s68, v9
    v_lshrrev_b32 v13, 2, v2
    v_lshl_add_u32 v8, v13, 2, v9
    v_mov_b32 v10, 0xff7fffff
    v_mov_b32 v11, 0
    v_and_b32 v1, 3, v2
    v_lshlrev_b32 v1, 5, v1
    v_lshl_add_u32 v1, v3, 7, v1
    s_waitcnt vmcnt(4)
    buffer_load_dwordx4 v[88:91], v5, s[36:39], s64 offen offset:2048 nt
    v_lshrrev_b32 v12, 3, v2
    v_mul_u32_u24 v12, 0x0202, v12
    v_add_u32 v12, 0x0100, v12
    v_lshlrev_b32 v13, 16, v12
    v_or_b32 v13, 0x0c0c, v13
    v_or_b32 v12, 0x0c0c0000, v12
    v_and_b32 v14, 1, v2
    v_cmp_eq_u32 vcc, 1, v14
    s_nop 1
    v_cndmask_b32 v12, v12, v13, vcc
    v_bfe_u32 v14, v2, 1, 2
    v_mov_b32 v13, 0x0c0c0c0c
    v_cmp_eq_u32 vcc, 0, v14
    s_nop 1
    v_cndmask_b32 v28, v13, v12, vcc
    v_cmp_eq_u32 vcc, 1, v14
    s_nop 1
    v_cndmask_b32 v29, v13, v12, vcc
    v_cmp_eq_u32 vcc, 2, v14
    s_nop 1
    v_cndmask_b32 v30, v13, v12, vcc
    v_cmp_eq_u32 vcc, 3, v14
    s_nop 1
    v_cndmask_b32 v31, v13, v12, vcc
    s_waitcnt vmcnt(4)
    buffer_load_dwordx4 v[92:95], v5, s[36:39], s64 offen offset:3072 nt
    s_waitcnt vmcnt(4)
    s_add_u32 s64, s64, 32768
    buffer_load_dwordx4 v[96:99], v4, s[36:39], s64 offen offset:0 nt
    s_waitcnt vmcnt(4)
    buffer_load_dwordx4 v[100:103], v4, s[36:39], s64 offen offset:1024 nt
    s_waitcnt vmcnt(4)
    buffer_load_dwordx4 v[104:107], v4, s[36:39], s64 offen offset:2048 nt
    s_waitcnt vmcnt(4)
    buffer_load_dwordx4 v[108:111], v4, s[36:39], s64 offen offset:3072 nt
    s_waitcnt vmcnt(4)
    buffer_load_dwordx4 v[112:115], v5, s[36:39], s64 offen offset:0 nt
    s_waitcnt vmcnt(4)
    buffer_load_dwordx4 v[116:119], v5, s[36:39], s64 offen offset:1024 nt
    s_waitcnt vmcnt(4)
    buffer_load_dwordx4 v[120:123], v5, s[36:39], s64 offen offset:2048 nt
    s_waitcnt vmcnt(4)
    buffer_load_dwordx4 v[124:127], v5, s[36:39], s64 offen offset:3072 nt
    s_waitcnt vmcnt(4)
    s_add_u32 s64, s64, 32768
    buffer_load_dwordx4 v[128:131], v4, s[36:39], s64 offen offset:0 nt
    s_waitcnt vmcnt(4)
    buffer_load_dwordx4 v[132:135], v4, s[36:39], s64 offen offset:1024 nt
    s_waitcnt vmcnt(4)
    buffer_load_dwordx4 v[136:139], v4, s[36:39], s64 offen offset:2048 nt
    s_waitcnt vmcnt(4)
    buffer_load_dwordx4 v[140:143], v4, s[36:39], s64 offen offset:3072 nt
    s_waitcnt vmcnt(4)
    buffer_load_dwordx4 v[144:147], v5, s[36:39], s64 offen offset:0 nt
    s_waitcnt vmcnt(4)
    buffer_load_dwordx4 v[148:151], v5, s[36:39], s64 offen offset:1024 nt
    s_waitcnt vmcnt(4)
    buffer_load_dwordx4 v[152:155], v5, s[36:39], s64 offen offset:2048 nt
    s_waitcnt vmcnt(4)
    buffer_load_dwordx4 v[156:159], v5, s[36:39], s64 offen offset:3072 nt
    s_waitcnt vmcnt(4)
    s_add_u32 s64, s64, 32768
    buffer_load_dwordx4 v[160:163], v4, s[36:39], s64 offen offset:0 nt
    s_waitcnt vmcnt(4)
    buffer_load_dwordx4 v[164:167], v4, s[36:39], s64 offen offset:1024 nt
    s_waitcnt vmcnt(4)
    buffer_load_dwordx4 v[168:171], v4, s[36:39], s64 offen offset:2048 nt
    s_waitcnt vmcnt(4)
    buffer_load_dwordx4 v[172:175], v4, s[36:39], s64 offen offset:3072 nt
    s_waitcnt vmcnt(4)
    buffer_load_dwordx4 v[176:179], v5, s[36:39], s64 offen offset:0 nt
    s_waitcnt vmcnt(4)
    buffer_load_dwordx4 v[180:183], v5, s[36:39], s64 offen offset:1024 nt
    s_waitcnt vmcnt(4)
    buffer_load_dwordx4 v[184:187], v5, s[36:39], s64 offen offset:2048 nt
    s_waitcnt vmcnt(4)
    buffer_load_dwordx4 v[188:191], v5, s[36:39], s64 offen offset:3072 nt
    s_waitcnt vmcnt(4)
    s_add_u32 s64, s64, 32768
    buffer_load_dwordx4 v[192:195], v4, s[36:39], s64 offen offset:0 nt
    s_waitcnt vmcnt(4)
    buffer_load_dwordx4 v[196:199], v4, s[36:39], s64 offen offset:1024 nt
    s_waitcnt vmcnt(4)
    buffer_load_dwordx4 v[200:203], v4, s[36:39], s64 offen offset:2048 nt
    s_waitcnt vmcnt(4)
    buffer_load_dwordx4 v[204:207], v4, s[36:39], s64 offen offset:3072 nt
    s_waitcnt vmcnt(4)
    buffer_load_dwordx4 v[208:211], v5, s[36:39], s64 offen offset:0 nt
    s_waitcnt vmcnt(4)
    buffer_load_dwordx4 v[212:215], v5, s[36:39], s64 offen offset:1024 nt
    s_waitcnt vmcnt(4)
    buffer_load_dwordx4 v[216:219], v5, s[36:39], s64 offen offset:2048 nt
    s_waitcnt vmcnt(4)
    buffer_load_dwordx4 v[220:223], v5, s[36:39], s64 offen offset:3072 nt
    s_waitcnt vmcnt(4)
    s_add_u32 s64, s64, 32768
    buffer_load_dwordx4 v[224:227], v4, s[36:39], s64 offen offset:0 nt
    s_waitcnt vmcnt(4)
    buffer_load_dwordx4 v[228:231], v4, s[36:39], s64 offen offset:1024 nt
    s_waitcnt vmcnt(4)
    buffer_load_dwordx4 v[232:235], v4, s[36:39], s64 offen offset:2048 nt
    s_waitcnt vmcnt(4)
    buffer_load_dwordx4 v[236:239], v4, s[36:39], s64 offen offset:3072 nt
    s_waitcnt vmcnt(4)
    buffer_load_dwordx4 v[240:243], v5, s[36:39], s64 offen offset:0 nt
    s_waitcnt vmcnt(4)
    buffer_load_dwordx4 v[244:247], v5, s[36:39], s64 offen offset:1024 nt
    s_waitcnt vmcnt(4)
    buffer_load_dwordx4 v[248:251], v5, s[36:39], s64 offen offset:2048 nt
    s_waitcnt vmcnt(4)
    buffer_load_dwordx4 v[252:255], v5, s[36:39], s64 offen offset:3072 nt
    s_waitcnt vmcnt(4)
    s_add_u32 s64, s64, 32768
    s_add_u32 m0, s54, 0x0
    s_nop 0
    buffer_load_dwordx4 v4, s[36:39], s64 offen offset:0 nt lds
    s_waitcnt vmcnt(4)
    s_add_u32 m0, s54, 0x0
    s_nop 0
    buffer_load_dwordx4 v4, s[36:39], s64 offen offset:1024 nt lds
    s_waitcnt vmcnt(4)
    s_add_u32 m0, s54, 0x0
    s_nop 0
    buffer_load_dwordx4 v4, s[36:39], s64 offen offset:2048 nt lds
    s_waitcnt vmcnt(4)
    s_add_u32 m0, s54, 0x0
    s_nop 0
    buffer_load_dwordx4 v4, s[36:39], s64 offen offset:3072 nt lds
    s_waitcnt vmcnt(4)
    s_add_u32 m0, s54, 0x1000
    s_nop 0
    buffer_load_dwordx4 v5, s[36:39], s64 offen offset:0 nt lds
    s_waitcnt vmcnt(4)
    s_add_u32 m0, s54, 0x1000
    s_nop 0
    buffer_load_dwordx4 v5, s[36:39], s64 offen offset:1024 nt lds
    s_waitcnt vmcnt(4)
    s_add_u32 m0, s54, 0x1000
    s_nop 0
    buffer_load_dwordx4 v5, s[36:39], s64 offen offset:2048 nt lds
    s_waitcnt vmcnt(4)
    s_add_u32 m0, s54, 0x1000
    s_nop 0
    buffer_load_dwordx4 v5, s[36:39], s64 offen offset:3072 nt lds
    s_waitcnt vmcnt(4)
    s_add_u32 s64, s64, 32768
    s_add_u32 m0, s54, 0x2000
    s_nop 0
    buffer_load_dwordx4 v4, s[36:39], s64 offen offset:0 nt lds
    s_waitcnt vmcnt(4)
    s_add_u32 m0, s54, 0x2000
    s_nop 0
    buffer_load_dwordx4 v4, s[36:39], s64 offen offset:1024 nt lds
    s_waitcnt vmcnt(4)
    s_add_u32 m0, s54, 0x2000
    s_nop 0
    buffer_load_dwordx4 v4, s[36:39], s64 offen offset:2048 nt lds
    s_waitcnt vmcnt(4)
    s_add_u32 m0, s54, 0x2000
    s_nop 0
    buffer_load_dwordx4 v4, s[36:39], s64 offen offset:3072 nt lds
    s_waitcnt vmcnt(4)
    s_add_u32 m0, s54, 0x3000
    s_nop 0
    buffer_load_dwordx4 v5, s[36:39], s64 offen offset:0 nt lds
    s_waitcnt vmcnt(4)
    s_add_u32 m0, s54, 0x3000
    s_nop 0
    buffer_load_dwordx4 v5, s[36:39], s64 offen offset:1024 nt lds
    s_waitcnt vmcnt(4)
    s_add_u32 m0, s54, 0x3000
    s_nop 0
    buffer_load_dwordx4 v5, s[36:39], s64 offen offset:2048 nt lds
    s_waitcnt vmcnt(4)
    s_add_u32 m0, s54, 0x3000
    s_nop 0
    buffer_load_dwordx4 v5, s[36:39], s64 offen offset:3072 nt lds
    s_barrier
    s_waitcnt vmcnt(4)
    s_add_u32 s64, s64, 32768
    s_add_u32 m0, s54, 0x4000
    s_nop 0
    buffer_load_dwordx4 v4, s[36:39], s64 offen offset:0 nt lds
    ds_read_b128 v[20:23], v1 offset:24832
    ds_read_b128 v[24:27], v1 offset:24848
    ds_read_b128 v[12:15], v1 offset:25344
    ds_read_b128 v[16:19], v1 offset:25360
    s_waitcnt vmcnt(4)
    s_add_u32 m0, s54, 0x4000
    s_nop 0
    buffer_load_dwordx4 v4, s[36:39], s64 offen offset:1024 nt lds
    s_waitcnt lgkmcnt(0)
    v_add_f32 v20, v20, v12
    v_add_f32 v21, v21, v13
    v_add_f32 v22, v22, v14
    v_add_f32 v23, v23, v15
    v_add_f32 v24, v24, v16
    v_add_f32 v25, v25, v17
    v_add_f32 v26, v26, v18
    v_add_f32 v27, v27, v19
    ds_read_b128 v[12:15], v1 offset:25856
    ds_read_b128 v[16:19], v1 offset:25872
    s_waitcnt vmcnt(4)
    s_add_u32 m0, s54, 0x4000
    s_nop 0
    buffer_load_dwordx4 v4, s[36:39], s64 offen offset:2048 nt lds
    s_waitcnt lgkmcnt(0)
    v_add_f32 v20, v20, v12
    v_add_f32 v21, v21, v13
    v_add_f32 v22, v22, v14
    v_add_f32 v23, v23, v15
    v_add_f32 v24, v24, v16
    v_add_f32 v25, v25, v17
    v_add_f32 v26, v26, v18
    v_add_f32 v27, v27, v19
    ds_read_b128 v[12:15], v1 offset:26368
    ds_read_b128 v[16:19], v1 offset:26384
    s_waitcnt vmcnt(4)
    s_add_u32 m0, s54, 0x4000
    s_nop 0
    buffer_load_dwordx4 v4, s[36:39], s64 offen offset:3072 nt lds
    s_waitcnt lgkmcnt(0)
    v_add_f32 v20, v20, v12
    v_add_f32 v21, v21, v13
    v_add_f32 v22, v22, v14
    v_add_f32 v23, v23, v15
    v_add_f32 v24, v24, v16
    v_add_f32 v25, v25, v17
    v_add_f32 v26, v26, v18
    v_add_f32 v27, v27, v19
    s_mov_b32 s68, 0x3e0293ee
    v_mul_f32 v20, s68, v20
    v_mul_f32 v21, s68, v21
    v_mul_f32 v22, s68, v22
    v_mul_f32 v23, s68, v23
    v_mul_f32 v24, s68, v24
    v_mul_f32 v25, s68, v25
    v_mul_f32 v26, s68, v26
    v_mul_f32 v27, s68, v27
    s_waitcnt vmcnt(4)
    s_add_u32 m0, s54, 0x5000
    s_nop 0
    buffer_load_dwordx4 v5, s[36:39], s64 offen offset:0 nt lds
    v_cvt_pk_bf16_f32 v12, v20, v21
    v_lshlrev_b32 v13, 16, v12
    v_and_b32 v14, 0xffff0000, v12
    v_sub_f32 v13, v20, v13
    v_sub_f32 v14, v21, v14
    v_cvt_pk_bf16_f32 v15, v13, v14
    v_cndmask_b32 v32, 0, v12, s[56:57]
    v_cndmask_b32 v36, 0, v15, s[56:57]
    v_cndmask_b32 v40, 0, v12, s[58:59]
    v_cndmask_b32 v44, 0, v15, s[58:59]
    v_cndmask_b32 v48, 0, v12, s[60:61]
    v_cndmask_b32 v52, 0, v15, s[60:61]
    v_cndmask_b32 v56, 0, v12, s[62:63]
    v_cndmask_b32 v60, 0, v15, s[62:63]
    s_waitcnt vmcnt(4)
    s_add_u32 m0, s54, 0x5000
    s_nop 0
    buffer_load_dwordx4 v5, s[36:39], s64 offen offset:1024 nt lds
    v_cvt_pk_bf16_f32 v12, v22, v23
    v_lshlrev_b32 v13, 16, v12
    v_and_b32 v14, 0xffff0000, v12
    v_sub_f32 v13, v22, v13
    v_sub_f32 v14, v23, v14
    v_cvt_pk_bf16_f32 v15, v13, v14
    v_cndmask_b32 v33, 0, v12, s[56:57]
    v_cndmask_b32 v37, 0, v15, s[56:57]
    v_cndmask_b32 v41, 0, v12, s[58:59]
    v_cndmask_b32 v45, 0, v15, s[58:59]
    v_cndmask_b32 v49, 0, v12, s[60:61]
    v_cndmask_b32 v53, 0, v15, s[60:61]
    v_cndmask_b32 v57, 0, v12, s[62:63]
    v_cndmask_b32 v61, 0, v15, s[62:63]
    s_waitcnt vmcnt(4)
    s_add_u32 m0, s54, 0x5000
    s_nop 0
    buffer_load_dwordx4 v5, s[36:39], s64 offen offset:2048 nt lds
    v_cvt_pk_bf16_f32 v12, v24, v25
    v_lshlrev_b32 v13, 16, v12
    v_and_b32 v14, 0xffff0000, v12
    v_sub_f32 v13, v24, v13
    v_sub_f32 v14, v25, v14
    v_cvt_pk_bf16_f32 v15, v13, v14
    v_cndmask_b32 v34, 0, v12, s[56:57]
    v_cndmask_b32 v38, 0, v15, s[56:57]
    v_cndmask_b32 v42, 0, v12, s[58:59]
    v_cndmask_b32 v46, 0, v15, s[58:59]
    v_cndmask_b32 v50, 0, v12, s[60:61]
    v_cndmask_b32 v54, 0, v15, s[60:61]
    v_cndmask_b32 v58, 0, v12, s[62:63]
    v_cndmask_b32 v62, 0, v15, s[62:63]
    s_waitcnt vmcnt(4)
    s_add_u32 m0, s54, 0x5000
    s_nop 0
    buffer_load_dwordx4 v5, s[36:39], s64 offen offset:3072 nt lds
    v_cvt_pk_bf16_f32 v12, v26, v27
    v_lshlrev_b32 v13, 16, v12
    v_and_b32 v14, 0xffff0000, v12
    v_sub_f32 v13, v26, v13
    v_sub_f32 v14, v27, v14
    v_cvt_pk_bf16_f32 v15, v13, v14
    v_cndmask_b32 v35, 0, v12, s[56:57]
    v_cndmask_b32 v39, 0, v15, s[56:57]
    v_cndmask_b32 v43, 0, v12, s[58:59]
    v_cndmask_b32 v47, 0, v15, s[58:59]
    v_cndmask_b32 v51, 0, v12, s[60:61]
    v_cndmask_b32 v55, 0, v15, s[60:61]
    v_cndmask_b32 v59, 0, v12, s[62:63]
    v_cndmask_b32 v63, 0, v15, s[62:63]
    s_waitcnt vmcnt(4)
    s_add_u32 s64, s64, 32768
    s_add_u32 m0, s54, 0x6000
    s_nop 0
    buffer_load_dwordx4 v4, s[36:39], s64 offen offset:0 nt lds
    s_waitcnt vmcnt(4)
    s_add_u32 m0, s54, 0x6000
    s_nop 0
    buffer_load_dwordx4 v4, s[36:39], s64 offen offset:1024 nt lds
    s_waitcnt vmcnt(4)
    s_add_u32 m0, s54, 0x6000
    s_nop 0
    buffer_load_dwordx4 v4, s[36:39], s64 offen offset:2048 nt lds
    s_waitcnt vmcnt(4)
    s_add_u32 m0, s54, 0x6000
    s_nop 0
    buffer_load_dwordx4 v4, s[36:39], s64 offen offset:3072 nt lds
    s_waitcnt vmcnt(4)
    s_add_u32 m0, s54, 0x7000
    s_nop 0
    buffer_load_dwordx4 v5, s[36:39], s64 offen offset:0 nt lds
    s_waitcnt vmcnt(4)
    s_add_u32 m0, s54, 0x7000
    s_nop 0
    buffer_load_dwordx4 v5, s[36:39], s64 offen offset:1024 nt lds
    s_waitcnt vmcnt(4)
    s_add_u32 m0, s54, 0x7000
    s_nop 0
    buffer_load_dwordx4 v5, s[36:39], s64 offen offset:2048 nt lds
    s_waitcnt vmcnt(4)
    s_add_u32 m0, s54, 0x7000
    s_nop 0
    buffer_load_dwordx4 v5, s[36:39], s64 offen offset:3072 nt lds
    v_lshlrev_b32 v1, 4, v0
    v_add_u32 v1, s54, v1
    v_mfma_f32_16x16x32_bf16 v[20:23], v[64:67], v[32:35], 0
    v_mfma_f32_16x16x32_bf16 v[20:23], v[64:67], v[36:39], v[20:23]
    v_mfma_f32_16x16x32_bf16 v[20:23], v[68:71], v[40:43], v[20:23]
    v_mfma_f32_16x16x32_bf16 v[20:23], v[68:71], v[44:47], v[20:23]
    v_mfma_f32_16x16x32_bf16 v[20:23], v[72:75], v[48:51], v[20:23]
    v_mfma_f32_16x16x32_bf16 v[20:23], v[72:75], v[52:55], v[20:23]
    v_mfma_f32_16x16x32_bf16 v[20:23], v[76:79], v[56:59], v[20:23]
    v_mfma_f32_16x16x32_bf16 v[20:23], v[76:79], v[60:63], v[20:23]
    v_mfma_f32_16x16x32_bf16 v[24:27], v[80:83], v[32:35], 0
    v_mfma_f32_16x16x32_bf16 v[24:27], v[80:83], v[36:39], v[24:27]
    v_mfma_f32_16x16x32_bf16 v[24:27], v[84:87], v[40:43], v[24:27]
    v_mfma_f32_16x16x32_bf16 v[24:27], v[84:87], v[44:47], v[24:27]
    v_mfma_f32_16x16x32_bf16 v[24:27], v[88:91], v[48:51], v[24:27]
    v_mfma_f32_16x16x32_bf16 v[24:27], v[88:91], v[52:55], v[24:27]
    v_mfma_f32_16x16x32_bf16 v[24:27], v[92:95], v[56:59], v[24:27]
    v_mfma_f32_16x16x32_bf16 v[24:27], v[92:95], v[60:63], v[24:27]
    s_nop 7
    v_cndmask_b32 v12, v20, v21, s[48:49]
    v_cndmask_b32 v12, v12, v22, s[50:51]
    v_cndmask_b32 v12, v12, v23, s[52:53]
    v_cndmask_b32 v13, v24, v25, s[48:49]
    v_cndmask_b32 v13, v13, v26, s[50:51]
    v_cndmask_b32 v13, v13, v27, s[52:53]
    s_nop 0
    v_add_f32_dpp v12, v12, v12 quad_perm:[1,0,3,2] row_mask:0xf bank_mask:0xf
    v_add_f32_dpp v13, v13, v13 quad_perm:[1,0,3,2] row_mask:0xf bank_mask:0xf
    s_nop 1
    v_add_f32_dpp v12, v12, v12 quad_perm:[2,3,0,1] row_mask:0xf bank_mask:0xf
    v_add_f32_dpp v13, v13, v13 quad_perm:[2,3,0,1] row_mask:0xf bank_mask:0xf
    v_max3_f32 v14, v10, v12, v13
    ds_write_b32 v8, v12 offset:0
    ds_write_b32 v8, v13 offset:16
    v_sub_f32 v15, v10, v14
    v_sub_f32 v16, v12, v14
    v_sub_f32 v17, v13, v14
    v_exp_f32 v15, v15
    v_exp_f32 v16, v16
    v_exp_f32 v17, v17
    v_mov_b32 v10, v14
    v_add_u32 v8, 32, v8
    v_fma_f32 v11, v11, v15, v16
    v_add_f32 v11, v11, v17
    s_waitcnt vmcnt(4)
    s_add_u32 s64, s64, 32768
    buffer_load_dwordx4 v[64:67], v4, s[36:39], s64 offen offset:0 nt
    v_mfma_f32_16x16x32_bf16 v[20:23], v[96:99], v[32:35], 0
    v_mfma_f32_16x16x32_bf16 v[20:23], v[96:99], v[36:39], v[20:23]
    v_mfma_f32_16x16x32_bf16 v[20:23], v[100:103], v[40:43], v[20:23]
    v_mfma_f32_16x16x32_bf16 v[20:23], v[100:103], v[44:47], v[20:23]
    v_mfma_f32_16x16x32_bf16 v[20:23], v[104:107], v[48:51], v[20:23]
    v_mfma_f32_16x16x32_bf16 v[20:23], v[104:107], v[52:55], v[20:23]
    v_mfma_f32_16x16x32_bf16 v[20:23], v[108:111], v[56:59], v[20:23]
    v_mfma_f32_16x16x32_bf16 v[20:23], v[108:111], v[60:63], v[20:23]
    v_mfma_f32_16x16x32_bf16 v[24:27], v[112:115], v[32:35], 0
    v_mfma_f32_16x16x32_bf16 v[24:27], v[112:115], v[36:39], v[24:27]
    v_mfma_f32_16x16x32_bf16 v[24:27], v[116:119], v[40:43], v[24:27]
    v_mfma_f32_16x16x32_bf16 v[24:27], v[116:119], v[44:47], v[24:27]
    v_mfma_f32_16x16x32_bf16 v[24:27], v[120:123], v[48:51], v[24:27]
    v_mfma_f32_16x16x32_bf16 v[24:27], v[120:123], v[52:55], v[24:27]
    v_mfma_f32_16x16x32_bf16 v[24:27], v[124:127], v[56:59], v[24:27]
    v_mfma_f32_16x16x32_bf16 v[24:27], v[124:127], v[60:63], v[24:27]
    s_nop 7
    v_cndmask_b32 v12, v20, v21, s[48:49]
    v_cndmask_b32 v12, v12, v22, s[50:51]
    v_cndmask_b32 v12, v12, v23, s[52:53]
    v_cndmask_b32 v13, v24, v25, s[48:49]
    v_cndmask_b32 v13, v13, v26, s[50:51]
    v_cndmask_b32 v13, v13, v27, s[52:53]
    s_nop 0
    v_add_f32_dpp v12, v12, v12 quad_perm:[1,0,3,2] row_mask:0xf bank_mask:0xf
    v_add_f32_dpp v13, v13, v13 quad_perm:[1,0,3,2] row_mask:0xf bank_mask:0xf
    s_nop 1
    v_add_f32_dpp v12, v12, v12 quad_perm:[2,3,0,1] row_mask:0xf bank_mask:0xf
    v_add_f32_dpp v13, v13, v13 quad_perm:[2,3,0,1] row_mask:0xf bank_mask:0xf
    v_max3_f32 v14, v10, v12, v13
    ds_write_b32 v8, v12 offset:0
    ds_write_b32 v8, v13 offset:16
    v_sub_f32 v15, v10, v14
    v_sub_f32 v16, v12, v14
    v_sub_f32 v17, v13, v14
    v_exp_f32 v15, v15
    v_exp_f32 v16, v16
    v_exp_f32 v17, v17
    v_mov_b32 v10, v14
    v_add_u32 v8, 32, v8
    v_fma_f32 v11, v11, v15, v16
    v_add_f32 v11, v11, v17
    s_waitcnt vmcnt(4)
    buffer_load_dwordx4 v[68:71], v4, s[36:39], s64 offen offset:1024 nt
    v_mfma_f32_16x16x32_bf16 v[20:23], v[128:131], v[32:35], 0
    v_mfma_f32_16x16x32_bf16 v[20:23], v[128:131], v[36:39], v[20:23]
    v_mfma_f32_16x16x32_bf16 v[20:23], v[132:135], v[40:43], v[20:23]
    v_mfma_f32_16x16x32_bf16 v[20:23], v[132:135], v[44:47], v[20:23]
    v_mfma_f32_16x16x32_bf16 v[20:23], v[136:139], v[48:51], v[20:23]
    v_mfma_f32_16x16x32_bf16 v[20:23], v[136:139], v[52:55], v[20:23]
    v_mfma_f32_16x16x32_bf16 v[20:23], v[140:143], v[56:59], v[20:23]
    v_mfma_f32_16x16x32_bf16 v[20:23], v[140:143], v[60:63], v[20:23]
    v_mfma_f32_16x16x32_bf16 v[24:27], v[144:147], v[32:35], 0
    v_mfma_f32_16x16x32_bf16 v[24:27], v[144:147], v[36:39], v[24:27]
    v_mfma_f32_16x16x32_bf16 v[24:27], v[148:151], v[40:43], v[24:27]
    v_mfma_f32_16x16x32_bf16 v[24:27], v[148:151], v[44:47], v[24:27]
    v_mfma_f32_16x16x32_bf16 v[24:27], v[152:155], v[48:51], v[24:27]
    v_mfma_f32_16x16x32_bf16 v[24:27], v[152:155], v[52:55], v[24:27]
    v_mfma_f32_16x16x32_bf16 v[24:27], v[156:159], v[56:59], v[24:27]
    v_mfma_f32_16x16x32_bf16 v[24:27], v[156:159], v[60:63], v[24:27]
    s_nop 7
    v_cndmask_b32 v12, v20, v21, s[48:49]
    v_cndmask_b32 v12, v12, v22, s[50:51]
    v_cndmask_b32 v12, v12, v23, s[52:53]
    v_cndmask_b32 v13, v24, v25, s[48:49]
    v_cndmask_b32 v13, v13, v26, s[50:51]
    v_cndmask_b32 v13, v13, v27, s[52:53]
    s_nop 0
    v_add_f32_dpp v12, v12, v12 quad_perm:[1,0,3,2] row_mask:0xf bank_mask:0xf
    v_add_f32_dpp v13, v13, v13 quad_perm:[1,0,3,2] row_mask:0xf bank_mask:0xf
    s_nop 1
    v_add_f32_dpp v12, v12, v12 quad_perm:[2,3,0,1] row_mask:0xf bank_mask:0xf
    v_add_f32_dpp v13, v13, v13 quad_perm:[2,3,0,1] row_mask:0xf bank_mask:0xf
    v_max3_f32 v14, v10, v12, v13
    ds_write_b32 v8, v12 offset:0
    ds_write_b32 v8, v13 offset:16
    v_sub_f32 v15, v10, v14
    v_sub_f32 v16, v12, v14
    v_sub_f32 v17, v13, v14
    v_exp_f32 v15, v15
    v_exp_f32 v16, v16
    v_exp_f32 v17, v17
    v_mov_b32 v10, v14
    v_add_u32 v8, 32, v8
    v_fma_f32 v11, v11, v15, v16
    v_add_f32 v11, v11, v17
    s_waitcnt vmcnt(4)
    buffer_load_dwordx4 v[72:75], v4, s[36:39], s64 offen offset:2048 nt
    v_mfma_f32_16x16x32_bf16 v[20:23], v[160:163], v[32:35], 0
    v_mfma_f32_16x16x32_bf16 v[20:23], v[160:163], v[36:39], v[20:23]
    v_mfma_f32_16x16x32_bf16 v[20:23], v[164:167], v[40:43], v[20:23]
    v_mfma_f32_16x16x32_bf16 v[20:23], v[164:167], v[44:47], v[20:23]
    v_mfma_f32_16x16x32_bf16 v[20:23], v[168:171], v[48:51], v[20:23]
    v_mfma_f32_16x16x32_bf16 v[20:23], v[168:171], v[52:55], v[20:23]
    v_mfma_f32_16x16x32_bf16 v[20:23], v[172:175], v[56:59], v[20:23]
    v_mfma_f32_16x16x32_bf16 v[20:23], v[172:175], v[60:63], v[20:23]
    v_mfma_f32_16x16x32_bf16 v[24:27], v[176:179], v[32:35], 0
    v_mfma_f32_16x16x32_bf16 v[24:27], v[176:179], v[36:39], v[24:27]
    v_mfma_f32_16x16x32_bf16 v[24:27], v[180:183], v[40:43], v[24:27]
    v_mfma_f32_16x16x32_bf16 v[24:27], v[180:183], v[44:47], v[24:27]
    v_mfma_f32_16x16x32_bf16 v[24:27], v[184:187], v[48:51], v[24:27]
    v_mfma_f32_16x16x32_bf16 v[24:27], v[184:187], v[52:55], v[24:27]
    v_mfma_f32_16x16x32_bf16 v[24:27], v[188:191], v[56:59], v[24:27]
    v_mfma_f32_16x16x32_bf16 v[24:27], v[188:191], v[60:63], v[24:27]
    s_nop 7
    v_cndmask_b32 v12, v20, v21, s[48:49]
    v_cndmask_b32 v12, v12, v22, s[50:51]
    v_cndmask_b32 v12, v12, v23, s[52:53]
    v_cndmask_b32 v13, v24, v25, s[48:49]
    v_cndmask_b32 v13, v13, v26, s[50:51]
    v_cndmask_b32 v13, v13, v27, s[52:53]
    s_nop 0
    v_add_f32_dpp v12, v12, v12 quad_perm:[1,0,3,2] row_mask:0xf bank_mask:0xf
    v_add_f32_dpp v13, v13, v13 quad_perm:[1,0,3,2] row_mask:0xf bank_mask:0xf
    s_nop 1
    v_add_f32_dpp v12, v12, v12 quad_perm:[2,3,0,1] row_mask:0xf bank_mask:0xf
    v_add_f32_dpp v13, v13, v13 quad_perm:[2,3,0,1] row_mask:0xf bank_mask:0xf
    v_max3_f32 v14, v10, v12, v13
    ds_write_b32 v8, v12 offset:0
    ds_write_b32 v8, v13 offset:16
    v_sub_f32 v15, v10, v14
    v_sub_f32 v16, v12, v14
    v_sub_f32 v17, v13, v14
    v_exp_f32 v15, v15
    v_exp_f32 v16, v16
    v_exp_f32 v17, v17
    v_mov_b32 v10, v14
    v_add_u32 v8, 32, v8
    v_fma_f32 v11, v11, v15, v16
    v_add_f32 v11, v11, v17
    s_waitcnt vmcnt(4)
    buffer_load_dwordx4 v[76:79], v4, s[36:39], s64 offen offset:3072 nt
    v_mfma_f32_16x16x32_bf16 v[20:23], v[192:195], v[32:35], 0
    v_mfma_f32_16x16x32_bf16 v[20:23], v[192:195], v[36:39], v[20:23]
    v_mfma_f32_16x16x32_bf16 v[20:23], v[196:199], v[40:43], v[20:23]
    v_mfma_f32_16x16x32_bf16 v[20:23], v[196:199], v[44:47], v[20:23]
    v_mfma_f32_16x16x32_bf16 v[20:23], v[200:203], v[48:51], v[20:23]
    v_mfma_f32_16x16x32_bf16 v[20:23], v[200:203], v[52:55], v[20:23]
    v_mfma_f32_16x16x32_bf16 v[20:23], v[204:207], v[56:59], v[20:23]
    v_mfma_f32_16x16x32_bf16 v[20:23], v[204:207], v[60:63], v[20:23]
    v_mfma_f32_16x16x32_bf16 v[24:27], v[208:211], v[32:35], 0
    v_mfma_f32_16x16x32_bf16 v[24:27], v[208:211], v[36:39], v[24:27]
    v_mfma_f32_16x16x32_bf16 v[24:27], v[212:215], v[40:43], v[24:27]
    v_mfma_f32_16x16x32_bf16 v[24:27], v[212:215], v[44:47], v[24:27]
    v_mfma_f32_16x16x32_bf16 v[24:27], v[216:219], v[48:51], v[24:27]
    v_mfma_f32_16x16x32_bf16 v[24:27], v[216:219], v[52:55], v[24:27]
    v_mfma_f32_16x16x32_bf16 v[24:27], v[220:223], v[56:59], v[24:27]
    v_mfma_f32_16x16x32_bf16 v[24:27], v[220:223], v[60:63], v[24:27]
    s_nop 7
    v_cndmask_b32 v12, v20, v21, s[48:49]
    v_cndmask_b32 v12, v12, v22, s[50:51]
    v_cndmask_b32 v12, v12, v23, s[52:53]
    v_cndmask_b32 v13, v24, v25, s[48:49]
    v_cndmask_b32 v13, v13, v26, s[50:51]
    v_cndmask_b32 v13, v13, v27, s[52:53]
    s_nop 0
    v_add_f32_dpp v12, v12, v12 quad_perm:[1,0,3,2] row_mask:0xf bank_mask:0xf
    v_add_f32_dpp v13, v13, v13 quad_perm:[1,0,3,2] row_mask:0xf bank_mask:0xf
    s_nop 1
    v_add_f32_dpp v12, v12, v12 quad_perm:[2,3,0,1] row_mask:0xf bank_mask:0xf
    v_add_f32_dpp v13, v13, v13 quad_perm:[2,3,0,1] row_mask:0xf bank_mask:0xf
    v_max3_f32 v14, v10, v12, v13
    ds_write_b32 v8, v12 offset:0
    ds_write_b32 v8, v13 offset:16
    v_sub_f32 v15, v10, v14
    v_sub_f32 v16, v12, v14
    v_sub_f32 v17, v13, v14
    v_exp_f32 v15, v15
    v_exp_f32 v16, v16
    v_exp_f32 v17, v17
    v_mov_b32 v10, v14
    v_add_u32 v8, 32, v8
    v_fma_f32 v11, v11, v15, v16
    v_add_f32 v11, v11, v17
    s_waitcnt vmcnt(4)
    buffer_load_dwordx4 v[80:83], v5, s[36:39], s64 offen offset:0 nt
    s_waitcnt vmcnt(29)
    ds_read_b128 v[128:131], v1 offset:0
    ds_read_b128 v[132:135], v1 offset:1024
    ds_read_b128 v[136:139], v1 offset:2048
    ds_read_b128 v[140:143], v1 offset:3072
    ds_read_b128 v[144:147], v1 offset:4096
    ds_read_b128 v[148:151], v1 offset:5120
    ds_read_b128 v[152:155], v1 offset:6144
    ds_read_b128 v[156:159], v1 offset:7168
    v_mfma_f32_16x16x32_bf16 v[20:23], v[224:227], v[32:35], 0
    v_mfma_f32_16x16x32_bf16 v[20:23], v[224:227], v[36:39], v[20:23]
    v_mfma_f32_16x16x32_bf16 v[20:23], v[228:231], v[40:43], v[20:23]
    v_mfma_f32_16x16x32_bf16 v[20:23], v[228:231], v[44:47], v[20:23]
    v_mfma_f32_16x16x32_bf16 v[20:23], v[232:235], v[48:51], v[20:23]
    v_mfma_f32_16x16x32_bf16 v[20:23], v[232:235], v[52:55], v[20:23]
    v_mfma_f32_16x16x32_bf16 v[20:23], v[236:239], v[56:59], v[20:23]
    v_mfma_f32_16x16x32_bf16 v[20:23], v[236:239], v[60:63], v[20:23]
    v_mfma_f32_16x16x32_bf16 v[24:27], v[240:243], v[32:35], 0
    v_mfma_f32_16x16x32_bf16 v[24:27], v[240:243], v[36:39], v[24:27]
    v_mfma_f32_16x16x32_bf16 v[24:27], v[244:247], v[40:43], v[24:27]
    v_mfma_f32_16x16x32_bf16 v[24:27], v[244:247], v[44:47], v[24:27]
    v_mfma_f32_16x16x32_bf16 v[24:27], v[248:251], v[48:51], v[24:27]
    v_mfma_f32_16x16x32_bf16 v[24:27], v[248:251], v[52:55], v[24:27]
    v_mfma_f32_16x16x32_bf16 v[24:27], v[252:255], v[56:59], v[24:27]
    v_mfma_f32_16x16x32_bf16 v[24:27], v[252:255], v[60:63], v[24:27]
    s_nop 7
    v_cndmask_b32 v12, v20, v21, s[48:49]
    v_cndmask_b32 v12, v12, v22, s[50:51]
    v_cndmask_b32 v12, v12, v23, s[52:53]
    v_cndmask_b32 v13, v24, v25, s[48:49]
    v_cndmask_b32 v13, v13, v26, s[50:51]
    v_cndmask_b32 v13, v13, v27, s[52:53]
    s_nop 0
    v_add_f32_dpp v12, v12, v12 quad_perm:[1,0,3,2] row_mask:0xf bank_mask:0xf
    v_add_f32_dpp v13, v13, v13 quad_perm:[1,0,3,2] row_mask:0xf bank_mask:0xf
    s_nop 1
    v_add_f32_dpp v12, v12, v12 quad_perm:[2,3,0,1] row_mask:0xf bank_mask:0xf
    v_add_f32_dpp v13, v13, v13 quad_perm:[2,3,0,1] row_mask:0xf bank_mask:0xf
    v_max3_f32 v14, v10, v12, v13
    ds_write_b32 v8, v12 offset:0
    ds_write_b32 v8, v13 offset:16
    v_sub_f32 v15, v10, v14
    v_sub_f32 v16, v12, v14
    v_sub_f32 v17, v13, v14
    v_exp_f32 v15, v15
    v_exp_f32 v16, v16
    v_exp_f32 v17, v17
    v_mov_b32 v10, v14
    v_add_u32 v8, 32, v8
    v_fma_f32 v11, v11, v15, v16
    v_add_f32 v11, v11, v17
    s_waitcnt vmcnt(4)
    buffer_load_dwordx4 v[84:87], v5, s[36:39], s64 offen offset:1024 nt
    s_waitcnt lgkmcnt(0)
    s_waitcnt vmcnt(22)
    ds_read_b128 v[160:163], v1 offset:8192
    ds_read_b128 v[164:167], v1 offset:9216
    ds_read_b128 v[168:171], v1 offset:10240
    ds_read_b128 v[172:175], v1 offset:11264
    ds_read_b128 v[176:179], v1 offset:12288
    ds_read_b128 v[180:183], v1 offset:13312
    ds_read_b128 v[184:187], v1 offset:14336
    ds_read_b128 v[188:191], v1 offset:15360
    v_mfma_f32_16x16x32_bf16 v[20:23], v[128:131], v[32:35], 0
    v_mfma_f32_16x16x32_bf16 v[20:23], v[128:131], v[36:39], v[20:23]
    v_mfma_f32_16x16x32_bf16 v[20:23], v[132:135], v[40:43], v[20:23]
    v_mfma_f32_16x16x32_bf16 v[20:23], v[132:135], v[44:47], v[20:23]
    v_mfma_f32_16x16x32_bf16 v[20:23], v[136:139], v[48:51], v[20:23]
    v_mfma_f32_16x16x32_bf16 v[20:23], v[136:139], v[52:55], v[20:23]
    v_mfma_f32_16x16x32_bf16 v[20:23], v[140:143], v[56:59], v[20:23]
    v_mfma_f32_16x16x32_bf16 v[20:23], v[140:143], v[60:63], v[20:23]
    v_mfma_f32_16x16x32_bf16 v[24:27], v[144:147], v[32:35], 0
    v_mfma_f32_16x16x32_bf16 v[24:27], v[144:147], v[36:39], v[24:27]
    v_mfma_f32_16x16x32_bf16 v[24:27], v[148:151], v[40:43], v[24:27]
    v_mfma_f32_16x16x32_bf16 v[24:27], v[148:151], v[44:47], v[24:27]
    v_mfma_f32_16x16x32_bf16 v[24:27], v[152:155], v[48:51], v[24:27]
    v_mfma_f32_16x16x32_bf16 v[24:27], v[152:155], v[52:55], v[24:27]
    v_mfma_f32_16x16x32_bf16 v[24:27], v[156:159], v[56:59], v[24:27]
    v_mfma_f32_16x16x32_bf16 v[24:27], v[156:159], v[60:63], v[24:27]
    s_nop 7
    v_cndmask_b32 v12, v20, v21, s[48:49]
    v_cndmask_b32 v12, v12, v22, s[50:51]
    v_cndmask_b32 v12, v12, v23, s[52:53]
    v_cndmask_b32 v13, v24, v25, s[48:49]
    v_cndmask_b32 v13, v13, v26, s[50:51]
    v_cndmask_b32 v13, v13, v27, s[52:53]
    s_nop 0
    v_add_f32_dpp v12, v12, v12 quad_perm:[1,0,3,2] row_mask:0xf bank_mask:0xf
    v_add_f32_dpp v13, v13, v13 quad_perm:[1,0,3,2] row_mask:0xf bank_mask:0xf
    s_nop 1
    v_add_f32_dpp v12, v12, v12 quad_perm:[2,3,0,1] row_mask:0xf bank_mask:0xf
    v_add_f32_dpp v13, v13, v13 quad_perm:[2,3,0,1] row_mask:0xf bank_mask:0xf
    v_max3_f32 v14, v10, v12, v13
    ds_write_b32 v8, v12 offset:0
    ds_write_b32 v8, v13 offset:16
    v_sub_f32 v15, v10, v14
    v_sub_f32 v16, v12, v14
    v_sub_f32 v17, v13, v14
    v_exp_f32 v15, v15
    v_exp_f32 v16, v16
    v_exp_f32 v17, v17
    v_mov_b32 v10, v14
    v_add_u32 v8, 32, v8
    v_fma_f32 v11, v11, v15, v16
    v_add_f32 v11, v11, v17
    s_waitcnt vmcnt(4)
    buffer_load_dwordx4 v[88:91], v5, s[36:39], s64 offen offset:2048 nt
    s_waitcnt lgkmcnt(0)
    s_waitcnt vmcnt(15)
    ds_read_b128 v[128:131], v1 offset:16384
    ds_read_b128 v[132:135], v1 offset:17408
    ds_read_b128 v[136:139], v1 offset:18432
    ds_read_b128 v[140:143], v1 offset:19456
    ds_read_b128 v[144:147], v1 offset:20480
    ds_read_b128 v[148:151], v1 offset:21504
    ds_read_b128 v[152:155], v1 offset:22528
    ds_read_b128 v[156:159], v1 offset:23552
    v_mfma_f32_16x16x32_bf16 v[20:23], v[160:163], v[32:35], 0
    v_mfma_f32_16x16x32_bf16 v[20:23], v[160:163], v[36:39], v[20:23]
    v_mfma_f32_16x16x32_bf16 v[20:23], v[164:167], v[40:43], v[20:23]
    v_mfma_f32_16x16x32_bf16 v[20:23], v[164:167], v[44:47], v[20:23]
    v_mfma_f32_16x16x32_bf16 v[20:23], v[168:171], v[48:51], v[20:23]
    v_mfma_f32_16x16x32_bf16 v[20:23], v[168:171], v[52:55], v[20:23]
    v_mfma_f32_16x16x32_bf16 v[20:23], v[172:175], v[56:59], v[20:23]
    v_mfma_f32_16x16x32_bf16 v[20:23], v[172:175], v[60:63], v[20:23]
    v_mfma_f32_16x16x32_bf16 v[24:27], v[176:179], v[32:35], 0
    v_mfma_f32_16x16x32_bf16 v[24:27], v[176:179], v[36:39], v[24:27]
    v_mfma_f32_16x16x32_bf16 v[24:27], v[180:183], v[40:43], v[24:27]
    v_mfma_f32_16x16x32_bf16 v[24:27], v[180:183], v[44:47], v[24:27]
    v_mfma_f32_16x16x32_bf16 v[24:27], v[184:187], v[48:51], v[24:27]
    v_mfma_f32_16x16x32_bf16 v[24:27], v[184:187], v[52:55], v[24:27]
    v_mfma_f32_16x16x32_bf16 v[24:27], v[188:191], v[56:59], v[24:27]
    v_mfma_f32_16x16x32_bf16 v[24:27], v[188:191], v[60:63], v[24:27]
    s_nop 7
    v_cndmask_b32 v12, v20, v21, s[48:49]
    v_cndmask_b32 v12, v12, v22, s[50:51]
    v_cndmask_b32 v12, v12, v23, s[52:53]
    v_cndmask_b32 v13, v24, v25, s[48:49]
    v_cndmask_b32 v13, v13, v26, s[50:51]
    v_cndmask_b32 v13, v13, v27, s[52:53]
    s_nop 0
    v_add_f32_dpp v12, v12, v12 quad_perm:[1,0,3,2] row_mask:0xf bank_mask:0xf
    v_add_f32_dpp v13, v13, v13 quad_perm:[1,0,3,2] row_mask:0xf bank_mask:0xf
    s_nop 1
    v_add_f32_dpp v12, v12, v12 quad_perm:[2,3,0,1] row_mask:0xf bank_mask:0xf
    v_add_f32_dpp v13, v13, v13 quad_perm:[2,3,0,1] row_mask:0xf bank_mask:0xf
    v_max3_f32 v14, v10, v12, v13
    ds_write_b32 v8, v12 offset:0
    ds_write_b32 v8, v13 offset:16
    v_sub_f32 v15, v10, v14
    v_sub_f32 v16, v12, v14
    v_sub_f32 v17, v13, v14
    v_exp_f32 v15, v15
    v_exp_f32 v16, v16
    v_exp_f32 v17, v17
    v_mov_b32 v10, v14
    v_add_u32 v8, 32, v8
    v_fma_f32 v11, v11, v15, v16
    v_add_f32 v11, v11, v17
    s_waitcnt vmcnt(4)
    buffer_load_dwordx4 v[92:95], v5, s[36:39], s64 offen offset:3072 nt
    s_waitcnt lgkmcnt(0)
    s_waitcnt vmcnt(8)
    ds_read_b128 v[160:163], v1 offset:24576
    ds_read_b128 v[164:167], v1 offset:25600
    ds_read_b128 v[168:171], v1 offset:26624
    ds_read_b128 v[172:175], v1 offset:27648
    ds_read_b128 v[176:179], v1 offset:28672
    ds_read_b128 v[180:183], v1 offset:29696
    ds_read_b128 v[184:187], v1 offset:30720
    ds_read_b128 v[188:191], v1 offset:31744
    v_mfma_f32_16x16x32_bf16 v[20:23], v[128:131], v[32:35], 0
    v_mfma_f32_16x16x32_bf16 v[20:23], v[128:131], v[36:39], v[20:23]
    v_mfma_f32_16x16x32_bf16 v[20:23], v[132:135], v[40:43], v[20:23]
    v_mfma_f32_16x16x32_bf16 v[20:23], v[132:135], v[44:47], v[20:23]
    v_mfma_f32_16x16x32_bf16 v[20:23], v[136:139], v[48:51], v[20:23]
    v_mfma_f32_16x16x32_bf16 v[20:23], v[136:139], v[52:55], v[20:23]
    v_mfma_f32_16x16x32_bf16 v[20:23], v[140:143], v[56:59], v[20:23]
    v_mfma_f32_16x16x32_bf16 v[20:23], v[140:143], v[60:63], v[20:23]
    v_mfma_f32_16x16x32_bf16 v[24:27], v[144:147], v[32:35], 0
    v_mfma_f32_16x16x32_bf16 v[24:27], v[144:147], v[36:39], v[24:27]
    v_mfma_f32_16x16x32_bf16 v[24:27], v[148:151], v[40:43], v[24:27]
    v_mfma_f32_16x16x32_bf16 v[24:27], v[148:151], v[44:47], v[24:27]
    v_mfma_f32_16x16x32_bf16 v[24:27], v[152:155], v[48:51], v[24:27]
    v_mfma_f32_16x16x32_bf16 v[24:27], v[152:155], v[52:55], v[24:27]
    v_mfma_f32_16x16x32_bf16 v[24:27], v[156:159], v[56:59], v[24:27]
    v_mfma_f32_16x16x32_bf16 v[24:27], v[156:159], v[60:63], v[24:27]
    s_nop 7
    v_cndmask_b32 v12, v20, v21, s[48:49]
    v_cndmask_b32 v12, v12, v22, s[50:51]
    v_cndmask_b32 v12, v12, v23, s[52:53]
    v_cndmask_b32 v13, v24, v25, s[48:49]
    v_cndmask_b32 v13, v13, v26, s[50:51]
    v_cndmask_b32 v13, v13, v27, s[52:53]
    s_nop 0
    v_add_f32_dpp v12, v12, v12 quad_perm:[1,0,3,2] row_mask:0xf bank_mask:0xf
    v_add_f32_dpp v13, v13, v13 quad_perm:[1,0,3,2] row_mask:0xf bank_mask:0xf
    s_nop 1
    v_add_f32_dpp v12, v12, v12 quad_perm:[2,3,0,1] row_mask:0xf bank_mask:0xf
    v_add_f32_dpp v13, v13, v13 quad_perm:[2,3,0,1] row_mask:0xf bank_mask:0xf
    v_max3_f32 v14, v10, v12, v13
    ds_write_b32 v8, v12 offset:0
    ds_write_b32 v8, v13 offset:16
    v_sub_f32 v15, v10, v14
    v_sub_f32 v16, v12, v14
    v_sub_f32 v17, v13, v14
    v_exp_f32 v15, v15
    v_exp_f32 v16, v16
    v_exp_f32 v17, v17
    v_mov_b32 v10, v14
    v_add_u32 v8, 32, v8
    v_fma_f32 v11, v11, v15, v16
    v_add_f32 v11, v11, v17
    s_waitcnt vmcnt(4)
    s_add_u32 s64, s64, 32768
    buffer_load_dwordx4 v[96:99], v4, s[36:39], s64 offen offset:0 nt
    s_waitcnt lgkmcnt(0)
    v_mfma_f32_16x16x32_bf16 v[20:23], v[160:163], v[32:35], 0
    v_mfma_f32_16x16x32_bf16 v[20:23], v[160:163], v[36:39], v[20:23]
    v_mfma_f32_16x16x32_bf16 v[20:23], v[164:167], v[40:43], v[20:23]
    v_mfma_f32_16x16x32_bf16 v[20:23], v[164:167], v[44:47], v[20:23]
    v_mfma_f32_16x16x32_bf16 v[20:23], v[168:171], v[48:51], v[20:23]
    v_mfma_f32_16x16x32_bf16 v[20:23], v[168:171], v[52:55], v[20:23]
    v_mfma_f32_16x16x32_bf16 v[20:23], v[172:175], v[56:59], v[20:23]
    v_mfma_f32_16x16x32_bf16 v[20:23], v[172:175], v[60:63], v[20:23]
    v_mfma_f32_16x16x32_bf16 v[24:27], v[176:179], v[32:35], 0
    v_mfma_f32_16x16x32_bf16 v[24:27], v[176:179], v[36:39], v[24:27]
    v_mfma_f32_16x16x32_bf16 v[24:27], v[180:183], v[40:43], v[24:27]
    v_mfma_f32_16x16x32_bf16 v[24:27], v[180:183], v[44:47], v[24:27]
    v_mfma_f32_16x16x32_bf16 v[24:27], v[184:187], v[48:51], v[24:27]
    v_mfma_f32_16x16x32_bf16 v[24:27], v[184:187], v[52:55], v[24:27]
    v_mfma_f32_16x16x32_bf16 v[24:27], v[188:191], v[56:59], v[24:27]
    v_mfma_f32_16x16x32_bf16 v[24:27], v[188:191], v[60:63], v[24:27]
    s_nop 7
    v_cndmask_b32 v12, v20, v21, s[48:49]
    v_cndmask_b32 v12, v12, v22, s[50:51]
    v_cndmask_b32 v12, v12, v23, s[52:53]
    v_cndmask_b32 v13, v24, v25, s[48:49]
    v_cndmask_b32 v13, v13, v26, s[50:51]
    v_cndmask_b32 v13, v13, v27, s[52:53]
    s_nop 0
    v_add_f32_dpp v12, v12, v12 quad_perm:[1,0,3,2] row_mask:0xf bank_mask:0xf
    v_add_f32_dpp v13, v13, v13 quad_perm:[1,0,3,2] row_mask:0xf bank_mask:0xf
    s_nop 1
    v_add_f32_dpp v12, v12, v12 quad_perm:[2,3,0,1] row_mask:0xf bank_mask:0xf
    v_add_f32_dpp v13, v13, v13 quad_perm:[2,3,0,1] row_mask:0xf bank_mask:0xf
    v_max3_f32 v14, v10, v12, v13
    ds_write_b32 v8, v12 offset:0
    ds_write_b32 v8, v13 offset:16
    v_sub_f32 v15, v10, v14
    v_sub_f32 v16, v12, v14
    v_sub_f32 v17, v13, v14
    v_exp_f32 v15, v15
    v_exp_f32 v16, v16
    v_exp_f32 v17, v17
    v_mov_b32 v10, v14
    v_add_u32 v8, 32, v8
    v_fma_f32 v11, v11, v15, v16
    v_add_f32 v11, v11, v17
    s_waitcnt vmcnt(4)
    buffer_load_dwordx4 v[100:103], v4, s[36:39], s64 offen offset:1024 nt
    s_waitcnt vmcnt(9)
    v_mfma_f32_16x16x32_bf16 v[20:23], v[64:67], v[32:35], 0
    v_mfma_f32_16x16x32_bf16 v[20:23], v[64:67], v[36:39], v[20:23]
    s_waitcnt vmcnt(8)
    v_mfma_f32_16x16x32_bf16 v[20:23], v[68:71], v[40:43], v[20:23]
    v_mfma_f32_16x16x32_bf16 v[20:23], v[68:71], v[44:47], v[20:23]
    s_waitcnt vmcnt(7)
    v_mfma_f32_16x16x32_bf16 v[20:23], v[72:75], v[48:51], v[20:23]
    v_mfma_f32_16x16x32_bf16 v[20:23], v[72:75], v[52:55], v[20:23]
    s_waitcnt vmcnt(6)
    v_mfma_f32_16x16x32_bf16 v[20:23], v[76:79], v[56:59], v[20:23]
    v_mfma_f32_16x16x32_bf16 v[20:23], v[76:79], v[60:63], v[20:23]
    s_waitcnt vmcnt(5)
    v_mfma_f32_16x16x32_bf16 v[24:27], v[80:83], v[32:35], 0
    v_mfma_f32_16x16x32_bf16 v[24:27], v[80:83], v[36:39], v[24:27]
    s_waitcnt vmcnt(4)
    s_waitcnt vmcnt(4)
    buffer_load_dwordx4 v[104:107], v4, s[36:39], s64 offen offset:2048 nt
    v_mfma_f32_16x16x32_bf16 v[24:27], v[84:87], v[40:43], v[24:27]
    v_mfma_f32_16x16x32_bf16 v[24:27], v[84:87], v[44:47], v[24:27]
    s_waitcnt vmcnt(4)
    s_waitcnt vmcnt(4)
    buffer_load_dwordx4 v[108:111], v4, s[36:39], s64 offen offset:3072 nt
    v_mfma_f32_16x16x32_bf16 v[24:27], v[88:91], v[48:51], v[24:27]
    v_mfma_f32_16x16x32_bf16 v[24:27], v[88:91], v[52:55], v[24:27]
    s_waitcnt vmcnt(4)
    s_waitcnt vmcnt(4)
    buffer_load_dwordx4 v[112:115], v5, s[36:39], s64 offen offset:0 nt
    v_mfma_f32_16x16x32_bf16 v[24:27], v[92:95], v[56:59], v[24:27]
    v_mfma_f32_16x16x32_bf16 v[24:27], v[92:95], v[60:63], v[24:27]
    s_nop 7
    v_cndmask_b32 v12, v20, v21, s[48:49]
    v_cndmask_b32 v12, v12, v22, s[50:51]
    v_cndmask_b32 v12, v12, v23, s[52:53]
    v_cndmask_b32 v13, v24, v25, s[48:49]
    v_cndmask_b32 v13, v13, v26, s[50:51]
    v_cndmask_b32 v13, v13, v27, s[52:53]
    s_nop 0
    v_add_f32_dpp v12, v12, v12 quad_perm:[1,0,3,2] row_mask:0xf bank_mask:0xf
    v_add_f32_dpp v13, v13, v13 quad_perm:[1,0,3,2] row_mask:0xf bank_mask:0xf
    s_nop 1
    v_add_f32_dpp v12, v12, v12 quad_perm:[2,3,0,1] row_mask:0xf bank_mask:0xf
    v_add_f32_dpp v13, v13, v13 quad_perm:[2,3,0,1] row_mask:0xf bank_mask:0xf
    v_max3_f32 v14, v10, v12, v13
    ds_write_b32 v8, v12 offset:0
    ds_write_b32 v8, v13 offset:16
    v_sub_f32 v15, v10, v14
    v_sub_f32 v16, v12, v14
    v_sub_f32 v17, v13, v14
    v_exp_f32 v15, v15
    v_exp_f32 v16, v16
    v_exp_f32 v17, v17
    v_mov_b32 v10, v14
    v_add_u32 v8, 32, v8
    v_fma_f32 v11, v11, v15, v16
    v_add_f32 v11, v11, v17
    s_waitcnt vmcnt(4)
    s_waitcnt vmcnt(4)
    buffer_load_dwordx4 v[116:119], v5, s[36:39], s64 offen offset:1024 nt
    v_mfma_f32_16x16x32_bf16 v[20:23], v[96:99], v[32:35], 0
    v_mfma_f32_16x16x32_bf16 v[20:23], v[96:99], v[36:39], v[20:23]
    s_waitcnt vmcnt(4)
    s_waitcnt vmcnt(4)
    buffer_load_dwordx4 v[120:123], v5, s[36:39], s64 offen offset:2048 nt
    v_mfma_f32_16x16x32_bf16 v[20:23], v[100:103], v[40:43], v[20:23]
    v_mfma_f32_16x16x32_bf16 v[20:23], v[100:103], v[44:47], v[20:23]
    s_waitcnt vmcnt(4)
    s_waitcnt vmcnt(4)
    buffer_load_dwordx4 v[124:127], v5, s[36:39], s64 offen offset:3072 nt
    v_mfma_f32_16x16x32_bf16 v[20:23], v[104:107], v[48:51], v[20:23]
    v_mfma_f32_16x16x32_bf16 v[20:23], v[104:107], v[52:55], v[20:23]
    s_waitcnt vmcnt(4)
    s_waitcnt vmcnt(4)
    s_add_u32 s64, s64, 32768
    buffer_load_dwordx4 v[64:67], v4, s[36:39], s64 offen offset:0 nt
    v_mfma_f32_16x16x32_bf16 v[20:23], v[108:111], v[56:59], v[20:23]
    v_mfma_f32_16x16x32_bf16 v[20:23], v[108:111], v[60:63], v[20:23]
    s_waitcnt vmcnt(4)
    s_waitcnt vmcnt(4)
    buffer_load_dwordx4 v[68:71], v4, s[36:39], s64 offen offset:1024 nt
    v_mfma_f32_16x16x32_bf16 v[24:27], v[112:115], v[32:35], 0
    v_mfma_f32_16x16x32_bf16 v[24:27], v[112:115], v[36:39], v[24:27]
    s_waitcnt vmcnt(4)
    s_waitcnt vmcnt(4)
    buffer_load_dwordx4 v[72:75], v4, s[36:39], s64 offen offset:2048 nt
    v_mfma_f32_16x16x32_bf16 v[24:27], v[116:119], v[40:43], v[24:27]
    v_mfma_f32_16x16x32_bf16 v[24:27], v[116:119], v[44:47], v[24:27]
    s_waitcnt vmcnt(4)
    s_waitcnt vmcnt(4)
    buffer_load_dwordx4 v[76:79], v4, s[36:39], s64 offen offset:3072 nt
    v_mfma_f32_16x16x32_bf16 v[24:27], v[120:123], v[48:51], v[24:27]
    v_mfma_f32_16x16x32_bf16 v[24:27], v[120:123], v[52:55], v[24:27]
    s_waitcnt vmcnt(4)
    s_waitcnt vmcnt(4)
    buffer_load_dwordx4 v[80:83], v5, s[36:39], s64 offen offset:0 nt
    v_mfma_f32_16x16x32_bf16 v[24:27], v[124:127], v[56:59], v[24:27]
    v_mfma_f32_16x16x32_bf16 v[24:27], v[124:127], v[60:63], v[24:27]
    s_nop 7
    v_cndmask_b32 v12, v20, v21, s[48:49]
    v_cndmask_b32 v12, v12, v22, s[50:51]
    v_cndmask_b32 v12, v12, v23, s[52:53]
    v_cndmask_b32 v13, v24, v25, s[48:49]
    v_cndmask_b32 v13, v13, v26, s[50:51]
    v_cndmask_b32 v13, v13, v27, s[52:53]
    s_nop 0
    v_add_f32_dpp v12, v12, v12 quad_perm:[1,0,3,2] row_mask:0xf bank_mask:0xf
    v_add_f32_dpp v13, v13, v13 quad_perm:[1,0,3,2] row_mask:0xf bank_mask:0xf
    s_nop 1
    v_add_f32_dpp v12, v12, v12 quad_perm:[2,3,0,1] row_mask:0xf bank_mask:0xf
    v_add_f32_dpp v13, v13, v13 quad_perm:[2,3,0,1] row_mask:0xf bank_mask:0xf
    v_max3_f32 v14, v10, v12, v13
    ds_write_b32 v8, v12 offset:0
    ds_write_b32 v8, v13 offset:16
    v_sub_f32 v15, v10, v14
    v_sub_f32 v16, v12, v14
    v_sub_f32 v17, v13, v14
    v_exp_f32 v15, v15
    v_exp_f32 v16, v16
    v_exp_f32 v17, v17
    v_mov_b32 v10, v14
    v_add_u32 v8, 32, v8
    v_fma_f32 v11, v11, v15, v16
    v_add_f32 v11, v11, v17
    s_lshl_b32 s68, s3, 2
    v_mov_b32 v15, s68
    v_mov_b32 v16, 1
    ds_write_b32 v15, v16 offset:26992
    s_mov_b32 s64, 393216
    s_mov_b32 s65, 425984
    s_waitcnt vmcnt(4)
    buffer_load_dwordx4 v[84:87], v5, s[36:39], s64 offen offset:1024 nt
    v_mfma_f32_16x16x32_bf16 v[20:23], v[64:67], v[32:35], 0
    v_mfma_f32_16x16x32_bf16 v[20:23], v[64:67], v[36:39], v[20:23]
    s_waitcnt vmcnt(4)
    buffer_load_dwordx4 v[88:91], v5, s[36:39], s64 offen offset:2048 nt
    v_mfma_f32_16x16x32_bf16 v[20:23], v[68:71], v[40:43], v[20:23]
    v_mfma_f32_16x16x32_bf16 v[20:23], v[68:71], v[44:47], v[20:23]
    s_waitcnt vmcnt(4)
    buffer_load_dwordx4 v[92:95], v5, s[36:39], s64 offen offset:3072 nt
    v_mfma_f32_16x16x32_bf16 v[20:23], v[72:75], v[48:51], v[20:23]
    v_mfma_f32_16x16x32_bf16 v[20:23], v[72:75], v[52:55], v[20:23]
    s_waitcnt vmcnt(4)
    buffer_load_dwordx4 v[64:67], v4, s[36:39], s65 offen offset:0 nt
    v_mfma_f32_16x16x32_bf16 v[20:23], v[76:79], v[56:59], v[20:23]
    v_mfma_f32_16x16x32_bf16 v[20:23], v[76:79], v[60:63], v[20:23]
    s_waitcnt vmcnt(4)
    buffer_load_dwordx4 v[68:71], v4, s[36:39], s65 offen offset:1024 nt
    v_mfma_f32_16x16x32_bf16 v[24:27], v[80:83], v[32:35], 0
    v_mfma_f32_16x16x32_bf16 v[24:27], v[80:83], v[36:39], v[24:27]
    s_waitcnt vmcnt(4)
    buffer_load_dwordx4 v[72:75], v4, s[36:39], s65 offen offset:2048 nt
    v_mfma_f32_16x16x32_bf16 v[24:27], v[84:87], v[40:43], v[24:27]
    v_mfma_f32_16x16x32_bf16 v[24:27], v[84:87], v[44:47], v[24:27]
    s_waitcnt vmcnt(4)
    buffer_load_dwordx4 v[76:79], v4, s[36:39], s65 offen offset:3072 nt
    v_mfma_f32_16x16x32_bf16 v[24:27], v[88:91], v[48:51], v[24:27]
    v_mfma_f32_16x16x32_bf16 v[24:27], v[88:91], v[52:55], v[24:27]
    s_waitcnt vmcnt(4)
    buffer_load_dwordx4 v[80:83], v5, s[36:39], s65 offen offset:0 nt
    v_mfma_f32_16x16x32_bf16 v[24:27], v[92:95], v[56:59], v[24:27]
    v_mfma_f32_16x16x32_bf16 v[24:27], v[92:95], v[60:63], v[24:27]
    s_mov_b32 s64, s65
    s_add_u32 s65, s65, 32768
L_kloop:
    s_waitcnt vmcnt(4)
    buffer_load_dwordx4 v[84:87], v5, s[36:39], s64 offen offset:1024 nt
    v_mfma_f32_16x16x32_bf16 v[96:99], v[64:67], v[32:35], 0
    v_mfma_f32_16x16x32_bf16 v[96:99], v[64:67], v[36:39], v[96:99]
    v_cndmask_b32 v12, v20, v21, s[48:49]
    v_cndmask_b32 v12, v12, v22, s[50:51]
    v_cndmask_b32 v12, v12, v23, s[52:53]
    s_waitcnt vmcnt(4)
    buffer_load_dwordx4 v[88:91], v5, s[36:39], s64 offen offset:2048 nt
    v_mfma_f32_16x16x32_bf16 v[96:99], v[68:71], v[40:43], v[96:99]
    v_mfma_f32_16x16x32_bf16 v[96:99], v[68:71], v[44:47], v[96:99]
    v_cndmask_b32 v13, v24, v25, s[48:49]
    v_cndmask_b32 v13, v13, v26, s[50:51]
    v_cndmask_b32 v13, v13, v27, s[52:53]
    s_waitcnt vmcnt(4)
    buffer_load_dwordx4 v[92:95], v5, s[36:39], s64 offen offset:3072 nt
    v_mfma_f32_16x16x32_bf16 v[96:99], v[72:75], v[48:51], v[96:99]
    v_mfma_f32_16x16x32_bf16 v[96:99], v[72:75], v[52:55], v[96:99]
    v_add_f32_dpp v12, v12, v12 quad_perm:[1,0,3,2] row_mask:0xf bank_mask:0xf
    v_add_f32_dpp v13, v13, v13 quad_perm:[1,0,3,2] row_mask:0xf bank_mask:0xf
    s_waitcnt vmcnt(4)
    buffer_load_dwordx4 v[64:67], v4, s[36:39], s65 offen offset:0 nt
    v_mfma_f32_16x16x32_bf16 v[96:99], v[76:79], v[56:59], v[96:99]
    v_mfma_f32_16x16x32_bf16 v[96:99], v[76:79], v[60:63], v[96:99]
    v_add_f32_dpp v12, v12, v12 quad_perm:[2,3,0,1] row_mask:0xf bank_mask:0xf
    v_add_f32_dpp v13, v13, v13 quad_perm:[2,3,0,1] row_mask:0xf bank_mask:0xf
    s_waitcnt vmcnt(4)
    buffer_load_dwordx4 v[68:71], v4, s[36:39], s65 offen offset:1024 nt
    v_mfma_f32_16x16x32_bf16 v[100:103], v[80:83], v[32:35], 0
    v_mfma_f32_16x16x32_bf16 v[100:103], v[80:83], v[36:39], v[100:103]
    v_max3_f32 v14, v10, v12, v13
    ds_write_b32 v8, v12 offset:0
    ds_write_b32 v8, v13 offset:16
    s_waitcnt vmcnt(4)
    buffer_load_dwordx4 v[72:75], v4, s[36:39], s65 offen offset:2048 nt
    v_mfma_f32_16x16x32_bf16 v[100:103], v[84:87], v[40:43], v[100:103]
    v_mfma_f32_16x16x32_bf16 v[100:103], v[84:87], v[44:47], v[100:103]
    v_sub_f32 v15, v10, v14
    v_sub_f32 v16, v12, v14
    v_sub_f32 v17, v13, v14
    s_waitcnt vmcnt(4)
    buffer_load_dwordx4 v[76:79], v4, s[36:39], s65 offen offset:3072 nt
    v_mfma_f32_16x16x32_bf16 v[100:103], v[88:91], v[48:51], v[100:103]
    v_mfma_f32_16x16x32_bf16 v[100:103], v[88:91], v[52:55], v[100:103]
    v_exp_f32 v15, v15
    v_exp_f32 v16, v16
    v_exp_f32 v17, v17
    v_mov_b32 v10, v14
    v_add_u32 v8, 32, v8
    s_waitcnt vmcnt(4)
    buffer_load_dwordx4 v[80:83], v5, s[36:39], s65 offen offset:0 nt
    v_mfma_f32_16x16x32_bf16 v[100:103], v[92:95], v[56:59], v[100:103]
    v_mfma_f32_16x16x32_bf16 v[100:103], v[92:95], v[60:63], v[100:103]
    v_fma_f32 v11, v11, v15, v16
    v_add_f32 v11, v11, v17
    s_mov_b32 s64, s65
    s_add_u32 s65, s65, 32768
    s_waitcnt vmcnt(4)
    buffer_load_dwordx4 v[84:87], v5, s[36:39], s64 offen offset:1024 nt
    v_mfma_f32_16x16x32_bf16 v[20:23], v[64:67], v[32:35], 0
    v_mfma_f32_16x16x32_bf16 v[20:23], v[64:67], v[36:39], v[20:23]
    v_cndmask_b32 v12, v96, v97, s[48:49]
    v_cndmask_b32 v12, v12, v98, s[50:51]
    v_cndmask_b32 v12, v12, v99, s[52:53]
    s_waitcnt vmcnt(4)
    buffer_load_dwordx4 v[88:91], v5, s[36:39], s64 offen offset:2048 nt
    v_mfma_f32_16x16x32_bf16 v[20:23], v[68:71], v[40:43], v[20:23]
    v_mfma_f32_16x16x32_bf16 v[20:23], v[68:71], v[44:47], v[20:23]
    v_cndmask_b32 v13, v100, v101, s[48:49]
    v_cndmask_b32 v13, v13, v102, s[50:51]
    v_cndmask_b32 v13, v13, v103, s[52:53]
    s_waitcnt vmcnt(4)
    buffer_load_dwordx4 v[92:95], v5, s[36:39], s64 offen offset:3072 nt
    v_mfma_f32_16x16x32_bf16 v[20:23], v[72:75], v[48:51], v[20:23]
    v_mfma_f32_16x16x32_bf16 v[20:23], v[72:75], v[52:55], v[20:23]
    v_add_f32_dpp v12, v12, v12 quad_perm:[1,0,3,2] row_mask:0xf bank_mask:0xf
    v_add_f32_dpp v13, v13, v13 quad_perm:[1,0,3,2] row_mask:0xf bank_mask:0xf
    s_waitcnt vmcnt(4)
    buffer_load_dwordx4 v[64:67], v4, s[36:39], s65 offen offset:0 nt
    v_mfma_f32_16x16x32_bf16 v[20:23], v[76:79], v[56:59], v[20:23]
    v_mfma_f32_16x16x32_bf16 v[20:23], v[76:79], v[60:63], v[20:23]
    v_add_f32_dpp v12, v12, v12 quad_perm:[2,3,0,1] row_mask:0xf bank_mask:0xf
    v_add_f32_dpp v13, v13, v13 quad_perm:[2,3,0,1] row_mask:0xf bank_mask:0xf
    s_waitcnt vmcnt(4)
    buffer_load_dwordx4 v[68:71], v4, s[36:39], s65 offen offset:1024 nt
    v_mfma_f32_16x16x32_bf16 v[24:27], v[80:83], v[32:35], 0
    v_mfma_f32_16x16x32_bf16 v[24:27], v[80:83], v[36:39], v[24:27]
    v_max3_f32 v14, v10, v12, v13
    ds_write_b32 v8, v12 offset:0
    ds_write_b32 v8, v13 offset:16
    s_waitcnt vmcnt(4)
    buffer_load_dwordx4 v[72:75], v4, s[36:39], s65 offen offset:2048 nt
    v_mfma_f32_16x16x32_bf16 v[24:27], v[84:87], v[40:43], v[24:27]
    v_mfma_f32_16x16x32_bf16 v[24:27], v[84:87], v[44:47], v[24:27]
    v_sub_f32 v15, v10, v14
    v_sub_f32 v16, v12, v14
    v_sub_f32 v17, v13, v14
    s_waitcnt vmcnt(4)
    buffer_load_dwordx4 v[76:79], v4, s[36:39], s65 offen offset:3072 nt
    v_mfma_f32_16x16x32_bf16 v[24:27], v[88:91], v[48:51], v[24:27]
    v_mfma_f32_16x16x32_bf16 v[24:27], v[88:91], v[52:55], v[24:27]
    v_exp_f32 v15, v15
    v_exp_f32 v16, v16
    v_exp_f32 v17, v17
    v_mov_b32 v10, v14
    v_add_u32 v8, 32, v8
    s_waitcnt vmcnt(4)
    buffer_load_dwordx4 v[80:83], v5, s[36:39], s65 offen offset:0 nt
    v_mfma_f32_16x16x32_bf16 v[24:27], v[92:95], v[56:59], v[24:27]
    v_mfma_f32_16x16x32_bf16 v[24:27], v[92:95], v[60:63], v[24:27]
    v_fma_f32 v11, v11, v15, v16
    v_add_f32 v11, v11, v17
    s_mov_b32 s64, s65
    s_add_u32 s65, s65, 32768
    s_cmp_lt_u32 s64, 1015808
    s_cbranch_scc1 L_kloop
    s_waitcnt vmcnt(4)
    buffer_load_dwordx4 v[84:87], v5, s[36:39], s64 offen offset:1024 nt
    v_mfma_f32_16x16x32_bf16 v[96:99], v[64:67], v[32:35], 0
    v_mfma_f32_16x16x32_bf16 v[96:99], v[64:67], v[36:39], v[96:99]
    v_cndmask_b32 v12, v20, v21, s[48:49]
    v_cndmask_b32 v12, v12, v22, s[50:51]
    v_cndmask_b32 v12, v12, v23, s[52:53]
    s_waitcnt vmcnt(4)
    buffer_load_dwordx4 v[88:91], v5, s[36:39], s64 offen offset:2048 nt
    v_mfma_f32_16x16x32_bf16 v[96:99], v[68:71], v[40:43], v[96:99]
    v_mfma_f32_16x16x32_bf16 v[96:99], v[68:71], v[44:47], v[96:99]
    v_cndmask_b32 v13, v24, v25, s[48:49]
    v_cndmask_b32 v13, v13, v26, s[50:51]
    v_cndmask_b32 v13, v13, v27, s[52:53]
    s_waitcnt vmcnt(4)
    buffer_load_dwordx4 v[92:95], v5, s[36:39], s64 offen offset:3072 nt
    v_mfma_f32_16x16x32_bf16 v[96:99], v[72:75], v[48:51], v[96:99]
    v_mfma_f32_16x16x32_bf16 v[96:99], v[72:75], v[52:55], v[96:99]
    v_add_f32_dpp v12, v12, v12 quad_perm:[1,0,3,2] row_mask:0xf bank_mask:0xf
    v_add_f32_dpp v13, v13, v13 quad_perm:[1,0,3,2] row_mask:0xf bank_mask:0xf
    s_waitcnt vmcnt(4)
    buffer_load_dwordx4 v[64:67], v6, s[40:43], 0 offen offset:0 nt
    v_mfma_f32_16x16x32_bf16 v[96:99], v[76:79], v[56:59], v[96:99]
    v_mfma_f32_16x16x32_bf16 v[96:99], v[76:79], v[60:63], v[96:99]
    v_add_f32_dpp v12, v12, v12 quad_perm:[2,3,0,1] row_mask:0xf bank_mask:0xf
    v_add_f32_dpp v13, v13, v13 quad_perm:[2,3,0,1] row_mask:0xf bank_mask:0xf
    s_waitcnt vmcnt(4)
    buffer_load_dwordx4 v[68:71], v6, s[40:43], 0 offen offset:1024 nt
    v_mfma_f32_16x16x32_bf16 v[100:103], v[80:83], v[32:35], 0
    v_mfma_f32_16x16x32_bf16 v[100:103], v[80:83], v[36:39], v[100:103]
    v_max3_f32 v14, v10, v12, v13
    ds_write_b32 v8, v12 offset:0
    ds_write_b32 v8, v13 offset:16
    s_waitcnt vmcnt(4)
    buffer_load_dwordx4 v[72:75], v6, s[40:43], 0 offen offset:2048 nt
    v_mfma_f32_16x16x32_bf16 v[100:103], v[84:87], v[40:43], v[100:103]
    v_mfma_f32_16x16x32_bf16 v[100:103], v[84:87], v[44:47], v[100:103]
    v_sub_f32 v15, v10, v14
    v_sub_f32 v16, v12, v14
    v_sub_f32 v17, v13, v14
    s_waitcnt vmcnt(4)
    buffer_load_dwordx4 v[76:79], v6, s[40:43], 0 offen offset:3072 nt
    v_mfma_f32_16x16x32_bf16 v[100:103], v[88:91], v[48:51], v[100:103]
    v_mfma_f32_16x16x32_bf16 v[100:103], v[88:91], v[52:55], v[100:103]
    v_exp_f32 v15, v15
    v_exp_f32 v16, v16
    v_exp_f32 v17, v17
    v_mov_b32 v10, v14
    v_add_u32 v8, 32, v8
    s_waitcnt vmcnt(4)
    buffer_load_dwordx4 v[80:83], v7, s[40:43], 0 offen offset:0 nt
    v_mfma_f32_16x16x32_bf16 v[100:103], v[92:95], v[56:59], v[100:103]
    v_mfma_f32_16x16x32_bf16 v[100:103], v[92:95], v[60:63], v[100:103]
    v_fma_f32 v11, v11, v15, v16
    v_add_f32 v11, v11, v17
    s_nop 7
    v_cndmask_b32 v12, v96, v97, s[48:49]
    v_cndmask_b32 v12, v12, v98, s[50:51]
    v_cndmask_b32 v12, v12, v99, s[52:53]
    v_cndmask_b32 v13, v100, v101, s[48:49]
    v_cndmask_b32 v13, v13, v102, s[50:51]
    v_cndmask_b32 v13, v13, v103, s[52:53]
    s_nop 1
    v_add_f32_dpp v12, v12, v12 quad_perm:[1,0,3,2] row_mask:0xf bank_mask:0xf
    v_add_f32_dpp v13, v13, v13 quad_perm:[1,0,3,2] row_mask:0xf bank_mask:0xf
    s_nop 1
    v_add_f32_dpp v12, v12, v12 quad_perm:[2,3,0,1] row_mask:0xf bank_mask:0xf
    v_add_f32_dpp v13, v13, v13 quad_perm:[2,3,0,1] row_mask:0xf bank_mask:0xf
    v_max3_f32 v14, v10, v12, v13
    ds_write_b32 v8, v12 offset:0
    ds_write_b32 v8, v13 offset:16
    v_sub_f32 v15, v10, v14
    v_sub_f32 v16, v12, v14
    v_sub_f32 v17, v13, v14
    v_exp_f32 v15, v15
    v_exp_f32 v16, v16
    v_exp_f32 v17, v17
    v_mov_b32 v10, v14
    v_add_u32 v8, 32, v8
    v_fma_f32 v11, v11, v15, v16
    v_add_f32 v11, v11, v17
    s_nop 1
    v_max_f32_dpp v14, v10, v10 row_half_mirror row_mask:0xf bank_mask:0xf
    s_nop 1
    v_max_f32_dpp v14, v14, v14 row_mirror row_mask:0xf bank_mask:0xf
    s_nop 1
    v_readlane_b32 s68, v14, 0
    v_readlane_b32 s69, v14, 16
    v_readlane_b32 s70, v14, 32
    v_readlane_b32 s71, v14, 48
    s_nop 1
    v_mov_b32 v18, s68
    v_max_f32 v18, s69, v18
    v_max_f32 v18, s70, v18
    v_max_f32 v18, s71, v18
    v_sub_f32 v15, v10, v18
    v_exp_f32 v15, v15
    s_nop 0
    v_mul_f32 v11, v11, v15
    s_nop 1
    v_add_f32_dpp v11, v11, v11 row_half_mirror row_mask:0xf bank_mask:0xf
    s_nop 1
    v_add_f32_dpp v11, v11, v11 row_mirror row_mask:0xf bank_mask:0xf
    s_nop 1
    v_readlane_b32 s68, v11, 0
    v_readlane_b32 s69, v11, 16
    v_readlane_b32 s70, v11, 32
    v_readlane_b32 s71, v11, 48
    s_nop 1
    v_mov_b32 v11, s68
    v_add_f32 v11, s69, v11
    v_add_f32 v11, s70, v11
    v_add_f32 v11, s71, v11
    s_lshl_b32 s68, s3, 3
    v_mov_b32 v56, s68
    v_mov_b32 v58, v18
    v_mov_b32 v59, v11
    ds_write_b64 v56, v[58:59] offset:26880
    s_lshl_b32 s68, s3, 2
    v_mov_b32 v56, s68
    v_mov_b32 v60, 1
    s_waitcnt lgkmcnt(0)
    ds_write_b32 v56, v60 offset:26912
    v_mov_b32 v20, 0
    v_mov_b32 v24, 0
    v_mov_b32 v21, 0
    v_mov_b32 v25, 0
    v_mov_b32 v22, 0
    v_mov_b32 v26, 0
    v_mov_b32 v23, 0
    v_mov_b32 v27, 0
    v_mov_b32 v19, 0
    ds_read_b128 v[36:39], v9 offset:0
    ds_read_b128 v[40:43], v9 offset:16
    v_add_u32 v9, 32, v9
    s_mov_b32 s64, 0
    s_mov_b32 s65, 32768
    v_mov_b32 v58, 0
L_vL:
    v_add_u32 v19, 2, v19
    ds_write_b32 v56, v19 offset:26960
    s_waitcnt lgkmcnt(0)
    ds_read_b128 v[44:47], v9 offset:0
    ds_read_b128 v[48:51], v9 offset:16
    v_add_u32 v9, 32, v9
    s_waitcnt vmcnt(4)
    buffer_load_dwordx4 v[84:87], v7, s[40:43], s64 offen offset:1024 nt
    v_sub_f32 v52, v36, v18
    v_exp_f32 v52, v52
    s_nop 0
    v_and_b32 v53, 0xffff0000, v52
    v_sub_f32 v54, v52, v53
    v_cvt_pk_bf16_f32 v55, v53, v54
    v_perm_b32 v32, v55, v55, v28
    v_perm_b32 v33, v55, v55, v29
    v_perm_b32 v34, v55, v55, v30
    v_perm_b32 v35, v55, v55, v31
    s_nop 1
    v_mfma_f32_16x16x32_bf16 v[20:23], v[64:67], v[32:35], v[20:23]
    s_waitcnt vmcnt(4)
    buffer_load_dwordx4 v[88:91], v7, s[40:43], s64 offen offset:2048 nt
    v_sub_f32 v52, v37, v18
    v_exp_f32 v52, v52
    s_nop 0
    v_and_b32 v53, 0xffff0000, v52
    v_sub_f32 v54, v52, v53
    v_cvt_pk_bf16_f32 v55, v53, v54
    v_perm_b32 v32, v55, v55, v28
    v_perm_b32 v33, v55, v55, v29
    v_perm_b32 v34, v55, v55, v30
    v_perm_b32 v35, v55, v55, v31
    s_nop 1
    v_mfma_f32_16x16x32_bf16 v[24:27], v[68:71], v[32:35], v[24:27]
    s_waitcnt vmcnt(4)
    buffer_load_dwordx4 v[92:95], v7, s[40:43], s64 offen offset:3072 nt
    v_sub_f32 v52, v38, v18
    v_exp_f32 v52, v52
    s_nop 0
    v_and_b32 v53, 0xffff0000, v52
    v_sub_f32 v54, v52, v53
    v_cvt_pk_bf16_f32 v55, v53, v54
    v_perm_b32 v32, v55, v55, v28
    v_perm_b32 v33, v55, v55, v29
    v_perm_b32 v34, v55, v55, v30
    v_perm_b32 v35, v55, v55, v31
    s_nop 1
    v_mfma_f32_16x16x32_bf16 v[20:23], v[72:75], v[32:35], v[20:23]
    s_waitcnt vmcnt(4)
    buffer_load_dwordx4 v[64:67], v6, s[40:43], s65 offen offset:0 nt
    v_sub_f32 v52, v39, v18
    v_exp_f32 v52, v52
    s_nop 0
    v_and_b32 v53, 0xffff0000, v52
    v_sub_f32 v54, v52, v53
    v_cvt_pk_bf16_f32 v55, v53, v54
    v_perm_b32 v32, v55, v55, v28
    v_perm_b32 v33, v55, v55, v29
    v_perm_b32 v34, v55, v55, v30
    v_perm_b32 v35, v55, v55, v31
    s_nop 1
    v_mfma_f32_16x16x32_bf16 v[24:27], v[76:79], v[32:35], v[24:27]
    s_waitcnt vmcnt(4)
    buffer_load_dwordx4 v[68:71], v6, s[40:43], s65 offen offset:1024 nt
    v_sub_f32 v52, v40, v18
    v_exp_f32 v52, v52
    s_nop 0
    v_and_b32 v53, 0xffff0000, v52
    v_sub_f32 v54, v52, v53
    v_cvt_pk_bf16_f32 v55, v53, v54
    v_perm_b32 v32, v55, v55, v28
    v_perm_b32 v33, v55, v55, v29
    v_perm_b32 v34, v55, v55, v30
    v_perm_b32 v35, v55, v55, v31
    s_nop 1
    v_mfma_f32_16x16x32_bf16 v[20:23], v[80:83], v[32:35], v[20:23]
    s_waitcnt vmcnt(4)
    buffer_load_dwordx4 v[72:75], v6, s[40:43], s65 offen offset:2048 nt
    v_sub_f32 v52, v41, v18
    v_exp_f32 v52, v52
    s_nop 0
    v_and_b32 v53, 0xffff0000, v52
    v_sub_f32 v54, v52, v53
    v_cvt_pk_bf16_f32 v55, v53, v54
    v_perm_b32 v32, v55, v55, v28
    v_perm_b32 v33, v55, v55, v29
    v_perm_b32 v34, v55, v55, v30
    v_perm_b32 v35, v55, v55, v31
    s_nop 1
    v_mfma_f32_16x16x32_bf16 v[24:27], v[84:87], v[32:35], v[24:27]
    s_waitcnt vmcnt(4)
    buffer_load_dwordx4 v[76:79], v6, s[40:43], s65 offen offset:3072 nt
    v_sub_f32 v52, v42, v18
    v_exp_f32 v52, v52
    s_nop 0
    v_and_b32 v53, 0xffff0000, v52
    v_sub_f32 v54, v52, v53
    v_cvt_pk_bf16_f32 v55, v53, v54
    v_perm_b32 v32, v55, v55, v28
    v_perm_b32 v33, v55, v55, v29
    v_perm_b32 v34, v55, v55, v30
    v_perm_b32 v35, v55, v55, v31
    s_nop 1
    v_mfma_f32_16x16x32_bf16 v[20:23], v[88:91], v[32:35], v[20:23]
    s_waitcnt vmcnt(4)
    buffer_load_dwordx4 v[80:83], v7, s[40:43], s65 offen offset:0 nt
    v_sub_f32 v52, v43, v18
    v_exp_f32 v52, v52
    s_nop 0
    v_and_b32 v53, 0xffff0000, v52
    v_sub_f32 v54, v52, v53
    v_cvt_pk_bf16_f32 v55, v53, v54
    v_perm_b32 v32, v55, v55, v28
    v_perm_b32 v33, v55, v55, v29
    v_perm_b32 v34, v55, v55, v30
    v_perm_b32 v35, v55, v55, v31
    s_nop 1
    v_mfma_f32_16x16x32_bf16 v[24:27], v[92:95], v[32:35], v[24:27]
    s_mov_b32 s64, s65
    s_add_u32 s65, s65, 32768
    s_waitcnt lgkmcnt(0)
    ds_read_b128 v[36:39], v9 offset:0
    ds_read_b128 v[40:43], v9 offset:16
    v_add_u32 v9, 32, v9
    s_waitcnt vmcnt(4)
    buffer_load_dwordx4 v[84:87], v7, s[40:43], s64 offen offset:1024 nt
    v_sub_f32 v52, v44, v18
    v_exp_f32 v52, v52
    s_nop 0
    v_and_b32 v53, 0xffff0000, v52
    v_sub_f32 v54, v52, v53
    v_cvt_pk_bf16_f32 v55, v53, v54
    v_perm_b32 v32, v55, v55, v28
    v_perm_b32 v33, v55, v55, v29
    v_perm_b32 v34, v55, v55, v30
    v_perm_b32 v35, v55, v55, v31
    s_nop 1
    v_mfma_f32_16x16x32_bf16 v[20:23], v[64:67], v[32:35], v[20:23]
    s_waitcnt vmcnt(4)
    buffer_load_dwordx4 v[88:91], v7, s[40:43], s64 offen offset:2048 nt
    v_sub_f32 v52, v45, v18
    v_exp_f32 v52, v52
    s_nop 0
    v_and_b32 v53, 0xffff0000, v52
    v_sub_f32 v54, v52, v53
    v_cvt_pk_bf16_f32 v55, v53, v54
    v_perm_b32 v32, v55, v55, v28
    v_perm_b32 v33, v55, v55, v29
    v_perm_b32 v34, v55, v55, v30
    v_perm_b32 v35, v55, v55, v31
    s_nop 1
    v_mfma_f32_16x16x32_bf16 v[24:27], v[68:71], v[32:35], v[24:27]
    s_waitcnt vmcnt(4)
    buffer_load_dwordx4 v[92:95], v7, s[40:43], s64 offen offset:3072 nt
    v_sub_f32 v52, v46, v18
    v_exp_f32 v52, v52
    s_nop 0
    v_and_b32 v53, 0xffff0000, v52
    v_sub_f32 v54, v52, v53
    v_cvt_pk_bf16_f32 v55, v53, v54
    v_perm_b32 v32, v55, v55, v28
    v_perm_b32 v33, v55, v55, v29
    v_perm_b32 v34, v55, v55, v30
    v_perm_b32 v35, v55, v55, v31
    s_nop 1
    v_mfma_f32_16x16x32_bf16 v[20:23], v[72:75], v[32:35], v[20:23]
    s_waitcnt vmcnt(4)
    buffer_load_dwordx4 v[64:67], v6, s[40:43], s65 offen offset:0 nt
    v_sub_f32 v52, v47, v18
    v_exp_f32 v52, v52
    s_nop 0
    v_and_b32 v53, 0xffff0000, v52
    v_sub_f32 v54, v52, v53
    v_cvt_pk_bf16_f32 v55, v53, v54
    v_perm_b32 v32, v55, v55, v28
    v_perm_b32 v33, v55, v55, v29
    v_perm_b32 v34, v55, v55, v30
    v_perm_b32 v35, v55, v55, v31
    s_nop 1
    v_mfma_f32_16x16x32_bf16 v[24:27], v[76:79], v[32:35], v[24:27]
    s_waitcnt vmcnt(4)
    buffer_load_dwordx4 v[68:71], v6, s[40:43], s65 offen offset:1024 nt
    v_sub_f32 v52, v48, v18
    v_exp_f32 v52, v52
    s_nop 0
    v_and_b32 v53, 0xffff0000, v52
    v_sub_f32 v54, v52, v53
    v_cvt_pk_bf16_f32 v55, v53, v54
    v_perm_b32 v32, v55, v55, v28
    v_perm_b32 v33, v55, v55, v29
    v_perm_b32 v34, v55, v55, v30
    v_perm_b32 v35, v55, v55, v31
    s_nop 1
    v_mfma_f32_16x16x32_bf16 v[20:23], v[80:83], v[32:35], v[20:23]
    s_waitcnt vmcnt(4)
    buffer_load_dwordx4 v[72:75], v6, s[40:43], s65 offen offset:2048 nt
    v_sub_f32 v52, v49, v18
    v_exp_f32 v52, v52
    s_nop 0
    v_and_b32 v53, 0xffff0000, v52
    v_sub_f32 v54, v52, v53
    v_cvt_pk_bf16_f32 v55, v53, v54
    v_perm_b32 v32, v55, v55, v28
    v_perm_b32 v33, v55, v55, v29
    v_perm_b32 v34, v55, v55, v30
    v_perm_b32 v35, v55, v55, v31
    s_nop 1
    v_mfma_f32_16x16x32_bf16 v[24:27], v[84:87], v[32:35], v[24:27]
    s_waitcnt vmcnt(4)
    buffer_load_dwordx4 v[76:79], v6, s[40:43], s65 offen offset:3072 nt
    v_sub_f32 v52, v50, v18
    v_exp_f32 v52, v52
    s_nop 0
    v_and_b32 v53, 0xffff0000, v52
    v_sub_f32 v54, v52, v53
    v_cvt_pk_bf16_f32 v55, v53, v54
    v_perm_b32 v32, v55, v55, v28
    v_perm_b32 v33, v55, v55, v29
    v_perm_b32 v34, v55, v55, v30
    v_perm_b32 v35, v55, v55, v31
    s_nop 1
    v_mfma_f32_16x16x32_bf16 v[20:23], v[88:91], v[32:35], v[20:23]
    s_waitcnt vmcnt(4)
    buffer_load_dwordx4 v[80:83], v7, s[40:43], s65 offen offset:0 nt
    v_sub_f32 v52, v51, v18
    v_exp_f32 v52, v52
    s_nop 0
    v_and_b32 v53, 0xffff0000, v52
    v_sub_f32 v54, v52, v53
    v_cvt_pk_bf16_f32 v55, v53, v54
    v_perm_b32 v32, v55, v55, v28
    v_perm_b32 v33, v55, v55, v29
    v_perm_b32 v34, v55, v55, v30
    v_perm_b32 v35, v55, v55, v31
    s_nop 1
    v_mfma_f32_16x16x32_bf16 v[24:27], v[92:95], v[32:35], v[24:27]
    s_mov_b32 s64, s65
    s_add_u32 s65, s65, 32768
    s_cmp_ge_u32 s64, 786432
    s_cbranch_scc1 L_vend_L
    s_branch L_vL
L_vend_L:
    s_waitcnt lgkmcnt(0)
    ds_read_b128 v[44:47], v9 offset:0
    ds_read_b128 v[48:51], v9 offset:16
    v_add_u32 v9, 32, v9
    s_waitcnt vmcnt(4)
    buffer_load_dwordx4 v[84:87], v7, s[40:43], s64 offen offset:1024 nt
    buffer_load_dwordx4 v[88:91], v7, s[40:43], s64 offen offset:2048 nt
    buffer_load_dwordx4 v[92:95], v7, s[40:43], s64 offen offset:3072 nt
    v_sub_f32 v52, v36, v18
    v_exp_f32 v52, v52
    s_nop 0
    v_and_b32 v53, 0xffff0000, v52
    v_sub_f32 v54, v52, v53
    v_cvt_pk_bf16_f32 v55, v53, v54
    v_perm_b32 v32, v55, v55, v28
    v_perm_b32 v33, v55, v55, v29
    v_perm_b32 v34, v55, v55, v30
    v_perm_b32 v35, v55, v55, v31
    s_nop 1
    v_mfma_f32_16x16x32_bf16 v[20:23], v[64:67], v[32:35], v[20:23]
    s_waitcnt vmcnt(6)
    buffer_load_dwordx4 v[64:67], v6, s[40:43], s65 offen offset:0 nt
    v_sub_f32 v52, v37, v18
    v_exp_f32 v52, v52
    s_nop 0
    v_and_b32 v53, 0xffff0000, v52
    v_sub_f32 v54, v52, v53
    v_cvt_pk_bf16_f32 v55, v53, v54
    v_perm_b32 v32, v55, v55, v28
    v_perm_b32 v33, v55, v55, v29
    v_perm_b32 v34, v55, v55, v30
    v_perm_b32 v35, v55, v55, v31
    s_nop 1
    v_mfma_f32_16x16x32_bf16 v[24:27], v[68:71], v[32:35], v[24:27]
    s_waitcnt vmcnt(6)
    buffer_load_dwordx4 v[68:71], v6, s[40:43], s65 offen offset:1024 nt
    v_sub_f32 v52, v38, v18
    v_exp_f32 v52, v52
    s_nop 0
    v_and_b32 v53, 0xffff0000, v52
    v_sub_f32 v54, v52, v53
    v_cvt_pk_bf16_f32 v55, v53, v54
    v_perm_b32 v32, v55, v55, v28
    v_perm_b32 v33, v55, v55, v29
    v_perm_b32 v34, v55, v55, v30
    v_perm_b32 v35, v55, v55, v31
    s_nop 1
    v_mfma_f32_16x16x32_bf16 v[20:23], v[72:75], v[32:35], v[20:23]
    s_waitcnt vmcnt(6)
    buffer_load_dwordx4 v[72:75], v6, s[40:43], s65 offen offset:2048 nt
    v_sub_f32 v52, v39, v18
    v_exp_f32 v52, v52
    s_nop 0
    v_and_b32 v53, 0xffff0000, v52
    v_sub_f32 v54, v52, v53
    v_cvt_pk_bf16_f32 v55, v53, v54
    v_perm_b32 v32, v55, v55, v28
    v_perm_b32 v33, v55, v55, v29
    v_perm_b32 v34, v55, v55, v30
    v_perm_b32 v35, v55, v55, v31
    s_nop 1
    v_mfma_f32_16x16x32_bf16 v[24:27], v[76:79], v[32:35], v[24:27]
    s_waitcnt vmcnt(6)
    buffer_load_dwordx4 v[76:79], v6, s[40:43], s65 offen offset:3072 nt
    v_sub_f32 v52, v40, v18
    v_exp_f32 v52, v52
    s_nop 0
    v_and_b32 v53, 0xffff0000, v52
    v_sub_f32 v54, v52, v53
    v_cvt_pk_bf16_f32 v55, v53, v54
    v_perm_b32 v32, v55, v55, v28
    v_perm_b32 v33, v55, v55, v29
    v_perm_b32 v34, v55, v55, v30
    v_perm_b32 v35, v55, v55, v31
    s_nop 1
    v_mfma_f32_16x16x32_bf16 v[20:23], v[80:83], v[32:35], v[20:23]
    s_waitcnt vmcnt(6)
    buffer_load_dwordx4 v[80:83], v7, s[40:43], s65 offen offset:0 nt
    v_sub_f32 v52, v41, v18
    v_exp_f32 v52, v52
    s_nop 0
    v_and_b32 v53, 0xffff0000, v52
    v_sub_f32 v54, v52, v53
    v_cvt_pk_bf16_f32 v55, v53, v54
    v_perm_b32 v32, v55, v55, v28
    v_perm_b32 v33, v55, v55, v29
    v_perm_b32 v34, v55, v55, v30
    v_perm_b32 v35, v55, v55, v31
    s_nop 1
    v_mfma_f32_16x16x32_bf16 v[24:27], v[84:87], v[32:35], v[24:27]
    s_waitcnt vmcnt(6)
    buffer_load_dwordx4 v[84:87], v7, s[40:43], s65 offen offset:1024 nt
    v_sub_f32 v52, v42, v18
    v_exp_f32 v52, v52
    s_nop 0
    v_and_b32 v53, 0xffff0000, v52
    v_sub_f32 v54, v52, v53
    v_cvt_pk_bf16_f32 v55, v53, v54
    v_perm_b32 v32, v55, v55, v28
    v_perm_b32 v33, v55, v55, v29
    v_perm_b32 v34, v55, v55, v30
    v_perm_b32 v35, v55, v55, v31
    s_nop 1
    v_mfma_f32_16x16x32_bf16 v[20:23], v[88:91], v[32:35], v[20:23]
    s_waitcnt vmcnt(6)
    buffer_load_dwordx4 v[88:91], v7, s[40:43], s65 offen offset:2048 nt
    v_sub_f32 v52, v43, v18
    v_exp_f32 v52, v52
    s_nop 0
    v_and_b32 v53, 0xffff0000, v52
    v_sub_f32 v54, v52, v53
    v_cvt_pk_bf16_f32 v55, v53, v54
    v_perm_b32 v32, v55, v55, v28
    v_perm_b32 v33, v55, v55, v29
    v_perm_b32 v34, v55, v55, v30
    v_perm_b32 v35, v55, v55, v31
    s_nop 1
    v_mfma_f32_16x16x32_bf16 v[24:27], v[92:95], v[32:35], v[24:27]
    s_mov_b32 s64, s65
    s_add_u32 s65, s65, 32768
    s_waitcnt lgkmcnt(0)
    ds_read_b128 v[36:39], v9 offset:0
    ds_read_b128 v[40:43], v9 offset:16
    v_add_u32 v9, 32, v9
    s_waitcnt vmcnt(6)
    buffer_load_dwordx4 v[92:95], v7, s[40:43], s64 offen offset:3072 nt
    v_sub_f32 v52, v44, v18
    v_exp_f32 v52, v52
    s_nop 0
    v_and_b32 v53, 0xffff0000, v52
    v_sub_f32 v54, v52, v53
    v_cvt_pk_bf16_f32 v55, v53, v54
    v_perm_b32 v32, v55, v55, v28
    v_perm_b32 v33, v55, v55, v29
    v_perm_b32 v34, v55, v55, v30
    v_perm_b32 v35, v55, v55, v31
    s_nop 1
    v_mfma_f32_16x16x32_bf16 v[20:23], v[64:67], v[32:35], v[20:23]
    s_waitcnt vmcnt(6)
    buffer_load_dwordx4 v[64:67], v6, s[40:43], s65 offen offset:0 nt
    v_sub_f32 v52, v45, v18
    v_exp_f32 v52, v52
    s_nop 0
    v_and_b32 v53, 0xffff0000, v52
    v_sub_f32 v54, v52, v53
    v_cvt_pk_bf16_f32 v55, v53, v54
    v_perm_b32 v32, v55, v55, v28
    v_perm_b32 v33, v55, v55, v29
    v_perm_b32 v34, v55, v55, v30
    v_perm_b32 v35, v55, v55, v31
    s_nop 1
    v_mfma_f32_16x16x32_bf16 v[24:27], v[68:71], v[32:35], v[24:27]
    s_waitcnt vmcnt(6)
    buffer_load_dwordx4 v[68:71], v6, s[40:43], s65 offen offset:1024 nt
    v_sub_f32 v52, v46, v18
    v_exp_f32 v52, v52
    s_nop 0
    v_and_b32 v53, 0xffff0000, v52
    v_sub_f32 v54, v52, v53
    v_cvt_pk_bf16_f32 v55, v53, v54
    v_perm_b32 v32, v55, v55, v28
    v_perm_b32 v33, v55, v55, v29
    v_perm_b32 v34, v55, v55, v30
    v_perm_b32 v35, v55, v55, v31
    s_nop 1
    v_mfma_f32_16x16x32_bf16 v[20:23], v[72:75], v[32:35], v[20:23]
    s_waitcnt vmcnt(6)
    buffer_load_dwordx4 v[72:75], v6, s[40:43], s65 offen offset:2048 nt
    v_sub_f32 v52, v47, v18
    v_exp_f32 v52, v52
    s_nop 0
    v_and_b32 v53, 0xffff0000, v52
    v_sub_f32 v54, v52, v53
    v_cvt_pk_bf16_f32 v55, v53, v54
    v_perm_b32 v32, v55, v55, v28
    v_perm_b32 v33, v55, v55, v29
    v_perm_b32 v34, v55, v55, v30
    v_perm_b32 v35, v55, v55, v31
    s_nop 1
    v_mfma_f32_16x16x32_bf16 v[24:27], v[76:79], v[32:35], v[24:27]
    s_waitcnt vmcnt(6)
    buffer_load_dwordx4 v[76:79], v6, s[40:43], s65 offen offset:3072 nt
    v_sub_f32 v52, v48, v18
    v_exp_f32 v52, v52
    s_nop 0
    v_and_b32 v53, 0xffff0000, v52
    v_sub_f32 v54, v52, v53
    v_cvt_pk_bf16_f32 v55, v53, v54
    v_perm_b32 v32, v55, v55, v28
    v_perm_b32 v33, v55, v55, v29
    v_perm_b32 v34, v55, v55, v30
    v_perm_b32 v35, v55, v55, v31
    s_nop 1
    v_mfma_f32_16x16x32_bf16 v[20:23], v[80:83], v[32:35], v[20:23]
    s_waitcnt vmcnt(6)
    buffer_load_dwordx4 v[80:83], v7, s[40:43], s65 offen offset:0 nt
    v_sub_f32 v52, v49, v18
    v_exp_f32 v52, v52
    s_nop 0
    v_and_b32 v53, 0xffff0000, v52
    v_sub_f32 v54, v52, v53
    v_cvt_pk_bf16_f32 v55, v53, v54
    v_perm_b32 v32, v55, v55, v28
    v_perm_b32 v33, v55, v55, v29
    v_perm_b32 v34, v55, v55, v30
    v_perm_b32 v35, v55, v55, v31
    s_nop 1
    v_mfma_f32_16x16x32_bf16 v[24:27], v[84:87], v[32:35], v[24:27]
    s_waitcnt vmcnt(6)
    buffer_load_dwordx4 v[84:87], v7, s[40:43], s65 offen offset:1024 nt
    v_sub_f32 v52, v50, v18
    v_exp_f32 v52, v52
    s_nop 0
    v_and_b32 v53, 0xffff0000, v52
    v_sub_f32 v54, v52, v53
    v_cvt_pk_bf16_f32 v55, v53, v54
    v_perm_b32 v32, v55, v55, v28
    v_perm_b32 v33, v55, v55, v29
    v_perm_b32 v34, v55, v55, v30
    v_perm_b32 v35, v55, v55, v31
    s_nop 1
    v_mfma_f32_16x16x32_bf16 v[20:23], v[88:91], v[32:35], v[20:23]
    s_waitcnt vmcnt(6)
    buffer_load_dwordx4 v[88:91], v7, s[40:43], s65 offen offset:2048 nt
    v_sub_f32 v52, v51, v18
    v_exp_f32 v52, v52
    s_nop 0
    v_and_b32 v53, 0xffff0000, v52
    v_sub_f32 v54, v52, v53
    v_cvt_pk_bf16_f32 v55, v53, v54
    v_perm_b32 v32, v55, v55, v28
    v_perm_b32 v33, v55, v55, v29
    v_perm_b32 v34, v55, v55, v30
    v_perm_b32 v35, v55, v55, v31
    s_nop 1
    v_mfma_f32_16x16x32_bf16 v[24:27], v[92:95], v[32:35], v[24:27]
    s_mov_b32 s64, s65
    s_add_u32 s65, s65, 32768
L_vend_J:
L_vloop2:
    s_waitcnt lgkmcnt(0)
    ds_read_b128 v[44:47], v9 offset:0
    ds_read_b128 v[48:51], v9 offset:16
    v_add_u32 v9, 32, v9
    s_waitcnt vmcnt(6)
    buffer_load_dwordx4 v[92:95], v7, s[40:43], s64 offen offset:3072 nt
    v_sub_f32 v52, v36, v18
    v_exp_f32 v52, v52
    s_nop 0
    v_and_b32 v53, 0xffff0000, v52
    v_sub_f32 v54, v52, v53
    v_cvt_pk_bf16_f32 v55, v53, v54
    v_perm_b32 v32, v55, v55, v28
    v_perm_b32 v33, v55, v55, v29
    v_perm_b32 v34, v55, v55, v30
    v_perm_b32 v35, v55, v55, v31
    s_nop 1
    v_mfma_f32_16x16x32_bf16 v[20:23], v[64:67], v[32:35], v[20:23]
    s_waitcnt vmcnt(6)
    buffer_load_dwordx4 v[64:67], v6, s[40:43], s65 offen offset:0 nt
    v_sub_f32 v52, v37, v18
    v_exp_f32 v52, v52
    s_nop 0
    v_and_b32 v53, 0xffff0000, v52
    v_sub_f32 v54, v52, v53
    v_cvt_pk_bf16_f32 v55, v53, v54
    v_perm_b32 v32, v55, v55, v28
    v_perm_b32 v33, v55, v55, v29
    v_perm_b32 v34, v55, v55, v30
    v_perm_b32 v35, v55, v55, v31
    s_nop 1
    v_mfma_f32_16x16x32_bf16 v[24:27], v[68:71], v[32:35], v[24:27]
    s_waitcnt vmcnt(6)
    buffer_load_dwordx4 v[68:71], v6, s[40:43], s65 offen offset:1024 nt
    v_sub_f32 v52, v38, v18
    v_exp_f32 v52, v52
    s_nop 0
    v_and_b32 v53, 0xffff0000, v52
    v_sub_f32 v54, v52, v53
    v_cvt_pk_bf16_f32 v55, v53, v54
    v_perm_b32 v32, v55, v55, v28
    v_perm_b32 v33, v55, v55, v29
    v_perm_b32 v34, v55, v55, v30
    v_perm_b32 v35, v55, v55, v31
    s_nop 1
    v_mfma_f32_16x16x32_bf16 v[20:23], v[72:75], v[32:35], v[20:23]
    s_waitcnt vmcnt(6)
    buffer_load_dwordx4 v[72:75], v6, s[40:43], s65 offen offset:2048 nt
    v_sub_f32 v52, v39, v18
    v_exp_f32 v52, v52
    s_nop 0
    v_and_b32 v53, 0xffff0000, v52
    v_sub_f32 v54, v52, v53
    v_cvt_pk_bf16_f32 v55, v53, v54
    v_perm_b32 v32, v55, v55, v28
    v_perm_b32 v33, v55, v55, v29
    v_perm_b32 v34, v55, v55, v30
    v_perm_b32 v35, v55, v55, v31
    s_nop 1
    v_mfma_f32_16x16x32_bf16 v[24:27], v[76:79], v[32:35], v[24:27]
    s_waitcnt vmcnt(6)
    buffer_load_dwordx4 v[76:79], v6, s[40:43], s65 offen offset:3072 nt
    v_sub_f32 v52, v40, v18
    v_exp_f32 v52, v52
    s_nop 0
    v_and_b32 v53, 0xffff0000, v52
    v_sub_f32 v54, v52, v53
    v_cvt_pk_bf16_f32 v55, v53, v54
    v_perm_b32 v32, v55, v55, v28
    v_perm_b32 v33, v55, v55, v29
    v_perm_b32 v34, v55, v55, v30
    v_perm_b32 v35, v55, v55, v31
    s_nop 1
    v_mfma_f32_16x16x32_bf16 v[20:23], v[80:83], v[32:35], v[20:23]
    s_waitcnt vmcnt(6)
    buffer_load_dwordx4 v[80:83], v7, s[40:43], s65 offen offset:0 nt
    v_sub_f32 v52, v41, v18
    v_exp_f32 v52, v52
    s_nop 0
    v_and_b32 v53, 0xffff0000, v52
    v_sub_f32 v54, v52, v53
    v_cvt_pk_bf16_f32 v55, v53, v54
    v_perm_b32 v32, v55, v55, v28
    v_perm_b32 v33, v55, v55, v29
    v_perm_b32 v34, v55, v55, v30
    v_perm_b32 v35, v55, v55, v31
    s_nop 1
    v_mfma_f32_16x16x32_bf16 v[24:27], v[84:87], v[32:35], v[24:27]
    s_waitcnt vmcnt(6)
    buffer_load_dwordx4 v[84:87], v7, s[40:43], s65 offen offset:1024 nt
    v_sub_f32 v52, v42, v18
    v_exp_f32 v52, v52
    s_nop 0
    v_and_b32 v53, 0xffff0000, v52
    v_sub_f32 v54, v52, v53
    v_cvt_pk_bf16_f32 v55, v53, v54
    v_perm_b32 v32, v55, v55, v28
    v_perm_b32 v33, v55, v55, v29
    v_perm_b32 v34, v55, v55, v30
    v_perm_b32 v35, v55, v55, v31
    s_nop 1
    v_mfma_f32_16x16x32_bf16 v[20:23], v[88:91], v[32:35], v[20:23]
    s_waitcnt vmcnt(6)
    buffer_load_dwordx4 v[88:91], v7, s[40:43], s65 offen offset:2048 nt
    v_sub_f32 v52, v43, v18
    v_exp_f32 v52, v52
    s_nop 0
    v_and_b32 v53, 0xffff0000, v52
    v_sub_f32 v54, v52, v53
    v_cvt_pk_bf16_f32 v55, v53, v54
    v_perm_b32 v32, v55, v55, v28
    v_perm_b32 v33, v55, v55, v29
    v_perm_b32 v34, v55, v55, v30
    v_perm_b32 v35, v55, v55, v31
    s_nop 1
    v_mfma_f32_16x16x32_bf16 v[24:27], v[92:95], v[32:35], v[24:27]
    s_mov_b32 s64, s65
    s_add_u32 s65, s65, 32768
    s_waitcnt lgkmcnt(0)
    ds_read_b128 v[36:39], v9 offset:0
    ds_read_b128 v[40:43], v9 offset:16
    v_add_u32 v9, 32, v9
    s_waitcnt vmcnt(6)
    buffer_load_dwordx4 v[92:95], v7, s[40:43], s64 offen offset:3072 nt
    v_sub_f32 v52, v44, v18
    v_exp_f32 v52, v52
    s_nop 0
    v_and_b32 v53, 0xffff0000, v52
    v_sub_f32 v54, v52, v53
    v_cvt_pk_bf16_f32 v55, v53, v54
    v_perm_b32 v32, v55, v55, v28
    v_perm_b32 v33, v55, v55, v29
    v_perm_b32 v34, v55, v55, v30
    v_perm_b32 v35, v55, v55, v31
    s_nop 1
    v_mfma_f32_16x16x32_bf16 v[20:23], v[64:67], v[32:35], v[20:23]
    s_waitcnt vmcnt(6)
    buffer_load_dwordx4 v[64:67], v6, s[40:43], s65 offen offset:0 nt
    v_sub_f32 v52, v45, v18
    v_exp_f32 v52, v52
    s_nop 0
    v_and_b32 v53, 0xffff0000, v52
    v_sub_f32 v54, v52, v53
    v_cvt_pk_bf16_f32 v55, v53, v54
    v_perm_b32 v32, v55, v55, v28
    v_perm_b32 v33, v55, v55, v29
    v_perm_b32 v34, v55, v55, v30
    v_perm_b32 v35, v55, v55, v31
    s_nop 1
    v_mfma_f32_16x16x32_bf16 v[24:27], v[68:71], v[32:35], v[24:27]
    s_waitcnt vmcnt(6)
    buffer_load_dwordx4 v[68:71], v6, s[40:43], s65 offen offset:1024 nt
    v_sub_f32 v52, v46, v18
    v_exp_f32 v52, v52
    s_nop 0
    v_and_b32 v53, 0xffff0000, v52
    v_sub_f32 v54, v52, v53
    v_cvt_pk_bf16_f32 v55, v53, v54
    v_perm_b32 v32, v55, v55, v28
    v_perm_b32 v33, v55, v55, v29
    v_perm_b32 v34, v55, v55, v30
    v_perm_b32 v35, v55, v55, v31
    s_nop 1
    v_mfma_f32_16x16x32_bf16 v[20:23], v[72:75], v[32:35], v[20:23]
    s_waitcnt vmcnt(6)
    buffer_load_dwordx4 v[72:75], v6, s[40:43], s65 offen offset:2048 nt
    v_sub_f32 v52, v47, v18
    v_exp_f32 v52, v52
    s_nop 0
    v_and_b32 v53, 0xffff0000, v52
    v_sub_f32 v54, v52, v53
    v_cvt_pk_bf16_f32 v55, v53, v54
    v_perm_b32 v32, v55, v55, v28
    v_perm_b32 v33, v55, v55, v29
    v_perm_b32 v34, v55, v55, v30
    v_perm_b32 v35, v55, v55, v31
    s_nop 1
    v_mfma_f32_16x16x32_bf16 v[24:27], v[76:79], v[32:35], v[24:27]
    s_waitcnt vmcnt(6)
    buffer_load_dwordx4 v[76:79], v6, s[40:43], s65 offen offset:3072 nt
    v_sub_f32 v52, v48, v18
    v_exp_f32 v52, v52
    s_nop 0
    v_and_b32 v53, 0xffff0000, v52
    v_sub_f32 v54, v52, v53
    v_cvt_pk_bf16_f32 v55, v53, v54
    v_perm_b32 v32, v55, v55, v28
    v_perm_b32 v33, v55, v55, v29
    v_perm_b32 v34, v55, v55, v30
    v_perm_b32 v35, v55, v55, v31
    s_nop 1
    v_mfma_f32_16x16x32_bf16 v[20:23], v[80:83], v[32:35], v[20:23]
    s_waitcnt vmcnt(6)
    buffer_load_dwordx4 v[80:83], v7, s[40:43], s65 offen offset:0 nt
    v_sub_f32 v52, v49, v18
    v_exp_f32 v52, v52
    s_nop 0
    v_and_b32 v53, 0xffff0000, v52
    v_sub_f32 v54, v52, v53
    v_cvt_pk_bf16_f32 v55, v53, v54
    v_perm_b32 v32, v55, v55, v28
    v_perm_b32 v33, v55, v55, v29
    v_perm_b32 v34, v55, v55, v30
    v_perm_b32 v35, v55, v55, v31
    s_nop 1
    v_mfma_f32_16x16x32_bf16 v[24:27], v[84:87], v[32:35], v[24:27]
    s_waitcnt vmcnt(6)
    buffer_load_dwordx4 v[84:87], v7, s[40:43], s65 offen offset:1024 nt
    v_sub_f32 v52, v50, v18
    v_exp_f32 v52, v52
    s_nop 0
    v_and_b32 v53, 0xffff0000, v52
    v_sub_f32 v54, v52, v53
    v_cvt_pk_bf16_f32 v55, v53, v54
    v_perm_b32 v32, v55, v55, v28
    v_perm_b32 v33, v55, v55, v29
    v_perm_b32 v34, v55, v55, v30
    v_perm_b32 v35, v55, v55, v31
    s_nop 1
    v_mfma_f32_16x16x32_bf16 v[20:23], v[88:91], v[32:35], v[20:23]
    s_waitcnt vmcnt(6)
    buffer_load_dwordx4 v[88:91], v7, s[40:43], s65 offen offset:2048 nt
    v_sub_f32 v52, v51, v18
    v_exp_f32 v52, v52
    s_nop 0
    v_and_b32 v53, 0xffff0000, v52
    v_sub_f32 v54, v52, v53
    v_cvt_pk_bf16_f32 v55, v53, v54
    v_perm_b32 v32, v55, v55, v28
    v_perm_b32 v33, v55, v55, v29
    v_perm_b32 v34, v55, v55, v30
    v_perm_b32 v35, v55, v55, v31
    s_nop 1
    v_mfma_f32_16x16x32_bf16 v[24:27], v[92:95], v[32:35], v[24:27]
    s_mov_b32 s64, s65
    s_add_u32 s65, s65, 32768
    s_cmp_lt_u32 s64, 983040
    s_cbranch_scc1 L_vloop2
    s_waitcnt lgkmcnt(0)
    ds_read_b128 v[44:47], v9 offset:0
    ds_read_b128 v[48:51], v9 offset:16
    v_add_u32 v9, 32, v9
    s_waitcnt vmcnt(6)
    buffer_load_dwordx4 v[92:95], v7, s[40:43], s64 offen offset:3072 nt
    v_sub_f32 v52, v36, v18
    v_exp_f32 v52, v52
    s_nop 0
    v_and_b32 v53, 0xffff0000, v52
    v_sub_f32 v54, v52, v53
    v_cvt_pk_bf16_f32 v55, v53, v54
    v_perm_b32 v32, v55, v55, v28
    v_perm_b32 v33, v55, v55, v29
    v_perm_b32 v34, v55, v55, v30
    v_perm_b32 v35, v55, v55, v31
    s_nop 1
    v_mfma_f32_16x16x32_bf16 v[20:23], v[64:67], v[32:35], v[20:23]
    s_waitcnt vmcnt(6)
    buffer_load_dwordx4 v[64:67], v6, s[40:43], s65 offen offset:0 nt
    v_sub_f32 v52, v37, v18
    v_exp_f32 v52, v52
    s_nop 0
    v_and_b32 v53, 0xffff0000, v52
    v_sub_f32 v54, v52, v53
    v_cvt_pk_bf16_f32 v55, v53, v54
    v_perm_b32 v32, v55, v55, v28
    v_perm_b32 v33, v55, v55, v29
    v_perm_b32 v34, v55, v55, v30
    v_perm_b32 v35, v55, v55, v31
    s_nop 1
    v_mfma_f32_16x16x32_bf16 v[24:27], v[68:71], v[32:35], v[24:27]
    s_waitcnt vmcnt(6)
    buffer_load_dwordx4 v[68:71], v6, s[40:43], s65 offen offset:1024 nt
    v_sub_f32 v52, v38, v18
    v_exp_f32 v52, v52
    s_nop 0
    v_and_b32 v53, 0xffff0000, v52
    v_sub_f32 v54, v52, v53
    v_cvt_pk_bf16_f32 v55, v53, v54
    v_perm_b32 v32, v55, v55, v28
    v_perm_b32 v33, v55, v55, v29
    v_perm_b32 v34, v55, v55, v30
    v_perm_b32 v35, v55, v55, v31
    s_nop 1
    v_mfma_f32_16x16x32_bf16 v[20:23], v[72:75], v[32:35], v[20:23]
    s_waitcnt vmcnt(6)
    buffer_load_dwordx4 v[72:75], v6, s[40:43], s65 offen offset:2048 nt
    v_sub_f32 v52, v39, v18
    v_exp_f32 v52, v52
    s_nop 0
    v_and_b32 v53, 0xffff0000, v52
    v_sub_f32 v54, v52, v53
    v_cvt_pk_bf16_f32 v55, v53, v54
    v_perm_b32 v32, v55, v55, v28
    v_perm_b32 v33, v55, v55, v29
    v_perm_b32 v34, v55, v55, v30
    v_perm_b32 v35, v55, v55, v31
    s_nop 1
    v_mfma_f32_16x16x32_bf16 v[24:27], v[76:79], v[32:35], v[24:27]
    s_waitcnt vmcnt(6)
    buffer_load_dwordx4 v[76:79], v6, s[40:43], s65 offen offset:3072 nt
    v_sub_f32 v52, v40, v18
    v_exp_f32 v52, v52
    s_nop 0
    v_and_b32 v53, 0xffff0000, v52
    v_sub_f32 v54, v52, v53
    v_cvt_pk_bf16_f32 v55, v53, v54
    v_perm_b32 v32, v55, v55, v28
    v_perm_b32 v33, v55, v55, v29
    v_perm_b32 v34, v55, v55, v30
    v_perm_b32 v35, v55, v55, v31
    s_nop 1
    v_mfma_f32_16x16x32_bf16 v[20:23], v[80:83], v[32:35], v[20:23]
    s_waitcnt vmcnt(6)
    buffer_load_dwordx4 v[80:83], v7, s[40:43], s65 offen offset:0 nt
    v_sub_f32 v52, v41, v18
    v_exp_f32 v52, v52
    s_nop 0
    v_and_b32 v53, 0xffff0000, v52
    v_sub_f32 v54, v52, v53
    v_cvt_pk_bf16_f32 v55, v53, v54
    v_perm_b32 v32, v55, v55, v28
    v_perm_b32 v33, v55, v55, v29
    v_perm_b32 v34, v55, v55, v30
    v_perm_b32 v35, v55, v55, v31
    s_nop 1
    v_mfma_f32_16x16x32_bf16 v[24:27], v[84:87], v[32:35], v[24:27]
    s_waitcnt vmcnt(6)
    buffer_load_dwordx4 v[84:87], v7, s[40:43], s65 offen offset:1024 nt
    v_sub_f32 v52, v42, v18
    v_exp_f32 v52, v52
    s_nop 0
    v_and_b32 v53, 0xffff0000, v52
    v_sub_f32 v54, v52, v53
    v_cvt_pk_bf16_f32 v55, v53, v54
    v_perm_b32 v32, v55, v55, v28
    v_perm_b32 v33, v55, v55, v29
    v_perm_b32 v34, v55, v55, v30
    v_perm_b32 v35, v55, v55, v31
    s_nop 1
    v_mfma_f32_16x16x32_bf16 v[20:23], v[88:91], v[32:35], v[20:23]
    s_waitcnt vmcnt(6)
    buffer_load_dwordx4 v[88:91], v7, s[40:43], s65 offen offset:2048 nt
    v_sub_f32 v52, v43, v18
    v_exp_f32 v52, v52
    s_nop 0
    v_and_b32 v53, 0xffff0000, v52
    v_sub_f32 v54, v52, v53
    v_cvt_pk_bf16_f32 v55, v53, v54
    v_perm_b32 v32, v55, v55, v28
    v_perm_b32 v33, v55, v55, v29
    v_perm_b32 v34, v55, v55, v30
    v_perm_b32 v35, v55, v55, v31
    s_nop 1
    v_mfma_f32_16x16x32_bf16 v[24:27], v[92:95], v[32:35], v[24:27]
    s_mov_b32 s64, s65
    s_waitcnt lgkmcnt(0)
    s_waitcnt vmcnt(6)
    buffer_load_dwordx4 v[92:95], v7, s[40:43], s64 offen offset:3072 nt
    v_sub_f32 v52, v44, v18
    v_exp_f32 v52, v52
    s_nop 0
    v_and_b32 v53, 0xffff0000, v52
    v_sub_f32 v54, v52, v53
    v_cvt_pk_bf16_f32 v55, v53, v54
    v_perm_b32 v32, v55, v55, v28
    v_perm_b32 v33, v55, v55, v29
    v_perm_b32 v34, v55, v55, v30
    v_perm_b32 v35, v55, v55, v31
    s_nop 1
    v_mfma_f32_16x16x32_bf16 v[20:23], v[64:67], v[32:35], v[20:23]
    s_waitcnt vmcnt(6)
    v_sub_f32 v52, v45, v18
    v_exp_f32 v52, v52
    s_nop 0
    v_and_b32 v53, 0xffff0000, v52
    v_sub_f32 v54, v52, v53
    v_cvt_pk_bf16_f32 v55, v53, v54
    v_perm_b32 v32, v55, v55, v28
    v_perm_b32 v33, v55, v55, v29
    v_perm_b32 v34, v55, v55, v30
    v_perm_b32 v35, v55, v55, v31
    s_nop 1
    v_mfma_f32_16x16x32_bf16 v[24:27], v[68:71], v[32:35], v[24:27]
    s_waitcnt vmcnt(5)
    v_sub_f32 v52, v46, v18
    v_exp_f32 v52, v52
    s_nop 0
    v_and_b32 v53, 0xffff0000, v52
    v_sub_f32 v54, v52, v53
    v_cvt_pk_bf16_f32 v55, v53, v54
    v_perm_b32 v32, v55, v55, v28
    v_perm_b32 v33, v55, v55, v29
    v_perm_b32 v34, v55, v55, v30
    v_perm_b32 v35, v55, v55, v31
    s_nop 1
    v_mfma_f32_16x16x32_bf16 v[20:23], v[72:75], v[32:35], v[20:23]
    s_waitcnt vmcnt(4)
    v_sub_f32 v52, v47, v18
    v_exp_f32 v52, v52
    s_nop 0
    v_and_b32 v53, 0xffff0000, v52
    v_sub_f32 v54, v52, v53
    v_cvt_pk_bf16_f32 v55, v53, v54
    v_perm_b32 v32, v55, v55, v28
    v_perm_b32 v33, v55, v55, v29
    v_perm_b32 v34, v55, v55, v30
    v_perm_b32 v35, v55, v55, v31
    s_nop 1
    v_mfma_f32_16x16x32_bf16 v[24:27], v[76:79], v[32:35], v[24:27]
    s_waitcnt vmcnt(3)
    v_sub_f32 v52, v48, v18
    v_exp_f32 v52, v52
    s_nop 0
    v_and_b32 v53, 0xffff0000, v52
    v_sub_f32 v54, v52, v53
    v_cvt_pk_bf16_f32 v55, v53, v54
    v_perm_b32 v32, v55, v55, v28
    v_perm_b32 v33, v55, v55, v29
    v_perm_b32 v34, v55, v55, v30
    v_perm_b32 v35, v55, v55, v31
    s_nop 1
    v_mfma_f32_16x16x32_bf16 v[20:23], v[80:83], v[32:35], v[20:23]
    s_waitcnt vmcnt(2)
    v_sub_f32 v52, v49, v18
    v_exp_f32 v52, v52
    s_nop 0
    v_and_b32 v53, 0xffff0000, v52
    v_sub_f32 v54, v52, v53
    v_cvt_pk_bf16_f32 v55, v53, v54
    v_perm_b32 v32, v55, v55, v28
    v_perm_b32 v33, v55, v55, v29
    v_perm_b32 v34, v55, v55, v30
    v_perm_b32 v35, v55, v55, v31
    s_nop 1
    v_mfma_f32_16x16x32_bf16 v[24:27], v[84:87], v[32:35], v[24:27]
    s_waitcnt vmcnt(1)
    v_sub_f32 v52, v50, v18
    v_exp_f32 v52, v52
    s_nop 0
    v_and_b32 v53, 0xffff0000, v52
    v_sub_f32 v54, v52, v53
    v_cvt_pk_bf16_f32 v55, v53, v54
    v_perm_b32 v32, v55, v55, v28
    v_perm_b32 v33, v55, v55, v29
    v_perm_b32 v34, v55, v55, v30
    v_perm_b32 v35, v55, v55, v31
    s_nop 1
    v_mfma_f32_16x16x32_bf16 v[20:23], v[88:91], v[32:35], v[20:23]
    s_waitcnt vmcnt(0)
    v_sub_f32 v52, v51, v18
    v_exp_f32 v52, v52
    s_nop 0
    v_and_b32 v53, 0xffff0000, v52
    v_sub_f32 v54, v52, v53
    v_cvt_pk_bf16_f32 v55, v53, v54
    v_perm_b32 v32, v55, v55, v28
    v_perm_b32 v33, v55, v55, v29
    v_perm_b32 v34, v55, v55, v30
    v_perm_b32 v35, v55, v55, v31
    s_nop 1
    v_mfma_f32_16x16x32_bf16 v[24:27], v[92:95], v[32:35], v[24:27]
    v_mov_b32 v56, 0
L_fr_poll:
    ds_read_b32 v57, v56 offset:26980
    s_lshl_b32 s68, s3, 2
    v_mov_b32 v58, s68
    ds_read_b32 v59, v58 offset:26944
    s_waitcnt lgkmcnt(0)
    v_cmp_eq_u32 vcc, 0, v57
    s_cbranch_vccnz L_fr_poll
    v_and_b32 v56, 7, v2
    v_lshlrev_b32 v56, 1, v56
    v_lshl_add_u32 v56, v3, 6, v56
    v_lshrrev_b32 v57, 3, v2
    v_lshl_add_u32 v56, v57, 8, v56
    s_lshl_b32 s68, s3, 9
    v_add_u32 v56, s68, v56
    s_mov_b32 s70, 0xff00ff00
    s_mov_b32 s71, 0xff00ff00
    v_add_f32 v20, v20, v24
    v_add_f32 v21, v21, v25
    v_add_f32 v22, v22, v26
    v_add_f32 v23, v23, v27
    s_nop 1
    v_add_f32_dpp v20, v20, v20 row_ror:8 row_mask:0xf bank_mask:0xf
    v_add_f32_dpp v21, v21, v21 row_ror:8 row_mask:0xf bank_mask:0xf
    v_add_f32_dpp v22, v22, v22 row_ror:8 row_mask:0xf bank_mask:0xf
    v_add_f32_dpp v23, v23, v23 row_ror:8 row_mask:0xf bank_mask:0xf
    v_mul_f32 v20, v20, v59
    v_mul_f32 v21, v21, v59
    v_mul_f32 v22, v22, v59
    v_mul_f32 v23, v23, v59
    v_cvt_pk_bf16_f32 v24, v20, v20
    v_and_b32 v25, 0xffff0000, v24
    v_sub_f32 v26, v20, v25
    v_cvt_pk_bf16_f32 v26, v26, v26
    v_cndmask_b32 v26, v24, v26, s[70:71]
    ds_write_b16 v56, v26 offset:28928
    v_cvt_pk_bf16_f32 v24, v21, v21
    v_and_b32 v25, 0xffff0000, v24
    v_sub_f32 v26, v21, v25
    v_cvt_pk_bf16_f32 v26, v26, v26
    v_cndmask_b32 v26, v24, v26, s[70:71]
    ds_write_b16 v56, v26 offset:28944
    v_cvt_pk_bf16_f32 v24, v22, v22
    v_and_b32 v25, 0xffff0000, v24
    v_sub_f32 v26, v22, v25
    v_cvt_pk_bf16_f32 v26, v26, v26
    v_cndmask_b32 v26, v24, v26, s[70:71]
    ds_write_b16 v56, v26 offset:28960
    v_cvt_pk_bf16_f32 v24, v23, v23
    v_and_b32 v25, 0xffff0000, v24
    v_sub_f32 v26, v23, v25
    v_cvt_pk_bf16_f32 v26, v26, v26
    v_cndmask_b32 v26, v24, v26, s[70:71]
    ds_write_b16 v56, v26 offset:28976
    s_waitcnt lgkmcnt(0)
    s_barrier
    s_endpgm
L_helper:
    s_sub_u32 s66, s3, 4
    v_lshlrev_b32 v48, 4, v0
    s_lshl_b32 s68, s33, 10
    s_mov_b32 s46, 0x400000
    s_mov_b32 s47, 0x00020000
    v_lshlrev_b32 v96, 18, v3
    v_lshl_add_u32 v96, v2, 4, v96
    s_lshl_b32 s67, s33, 2
    s_add_u32 s67, s67, s34
    s_waitcnt lgkmcnt(0)
    s_add_u32 s70, s8, s68
    s_addc_u32 s71, s9, 0
    global_load_dwordx4 v[52:55], v48, s[70:71]
    s_mov_b32 s44, s14
    s_mov_b32 s45, s15
    s_lshl_b32 s68, s66, 20
    s_lshl_b32 s69, s32, 8
    s_add_u32 s68, s68, s69
    s_add_u32 s69, s67, 0
    s_and_b32 s69, s69, 7
    s_lshl_b32 s69, s69, 15
    s_add_u32 s69, s69, s68
    buffer_load_dwordx4 v[128:131], v96, s[44:47], s69 offen
    v_lshrrev_b32 v56, 3, v2
    v_mul_u32_u24 v56, 0x0202, v56
    v_add_u32 v56, 0x0100, v56
    v_lshlrev_b32 v57, 16, v56
    v_or_b32 v57, 0x0c0c, v57
    v_or_b32 v56, 0x0c0c0000, v56
    v_and_b32 v58, 1, v2
    v_cmp_eq_u32 vcc, 1, v58
    s_nop 1
    v_cndmask_b32 v56, v56, v57, vcc
    v_bfe_u32 v58, v2, 1, 2
    v_mov_b32 v57, 0x0c0c0c0c
    v_cmp_eq_u32 vcc, 0, v58
    s_nop 1
    v_cndmask_b32 v4, v57, v56, vcc
    v_cmp_eq_u32 vcc, 1, v58
    s_nop 1
    v_cndmask_b32 v5, v57, v56, vcc
    v_cmp_eq_u32 vcc, 2, v58
    s_nop 1
    v_cndmask_b32 v6, v57, v56, vcc
    v_cmp_eq_u32 vcc, 3, v58
    s_nop 1
    v_cndmask_b32 v7, v57, v56, vcc
    s_add_u32 s69, s69, 8192
    buffer_load_dwordx4 v[132:135], v96, s[44:47], s69 offen
    s_cmp_lg_u32 s66, 0
    s_cbranch_scc1 L_h_noclr
    v_mov_b32 v56, 0
    v_mov_b32 v57, 0
    v_mov_b32 v58, 0
    v_mov_b32 v59, 0
    ds_write_b128 v48, v[56:59] offset:26880
    ds_write_b128 v48, v[56:59] offset:27904
L_h_noclr:
    v_and_b32 v98, 7, v2
    v_lshlrev_b32 v98, 2, v98
    v_lshl_add_u32 v98, v3, 7, v98
    s_add_u32 s69, s69, 8192
    buffer_load_dwordx4 v[136:139], v96, s[44:47], s69 offen
    s_waitcnt vmcnt(2)
    s_add_u32 s69, s69, 8192
    buffer_load_dwordx4 v[140:143], v96, s[44:47], s69 offen
    v_lshlrev_b32 v56, 16, v52
    v_and_b32 v57, 0xffff0000, v52
    v_lshlrev_b32 v58, 16, v53
    v_and_b32 v59, 0xffff0000, v53
    v_lshlrev_b32 v60, 16, v54
    v_and_b32 v61, 0xffff0000, v54
    v_lshlrev_b32 v62, 16, v55
    v_and_b32 v63, 0xffff0000, v55
    v_add_f32 v64, v56, v57
    v_add_f32 v64, v64, v58
    v_add_f32 v64, v64, v59
    v_add_f32 v64, v64, v60
    v_add_f32 v64, v64, v61
    v_add_f32 v64, v64, v62
    v_add_f32 v64, v64, v63
    s_waitcnt vmcnt(2)
    s_add_u32 s69, s67, 1
    s_and_b32 s69, s69, 7
    s_lshl_b32 s69, s69, 15
    s_add_u32 s69, s69, s68
    buffer_load_dwordx4 v[144:147], v96, s[44:47], s69 offen
    s_nop 1
    v_add_f32_dpp v64, v64, v64 quad_perm:[1,0,3,2] row_mask:0xf bank_mask:0xf
    s_nop 1
    v_add_f32_dpp v64, v64, v64 quad_perm:[2,3,0,1] row_mask:0xf bank_mask:0xf
    s_nop 1
    v_add_f32_dpp v64, v64, v64 row_half_mirror row_mask:0xf bank_mask:0xf
    s_nop 1
    v_add_f32_dpp v64, v64, v64 row_mirror row_mask:0xf bank_mask:0xf
    s_nop 1
    v_readlane_b32 s72, v64, 0
    v_readlane_b32 s73, v64, 16
    v_readlane_b32 s74, v64, 32
    v_readlane_b32 s75, v64, 48
    s_nop 1
    v_mov_b32 v64, s72
    v_add_f32 v64, s73, v64
    v_add_f32 v64, s74, v64
    v_add_f32 v64, s75, v64
    s_waitcnt vmcnt(2)
    s_add_u32 s69, s69, 8192
    buffer_load_dwordx4 v[148:151], v96, s[44:47], s69 offen
    v_mul_f32 v64, 0x3b000000, v64
    v_sub_f32 v56, v56, v64
    v_sub_f32 v57, v57, v64
    v_sub_f32 v58, v58, v64
    v_sub_f32 v59, v59, v64
    v_sub_f32 v60, v60, v64
    v_sub_f32 v61, v61, v64
    v_sub_f32 v62, v62, v64
    v_sub_f32 v63, v63, v64
    v_mul_f32 v65, v56, v56
    v_fmac_f32 v65, v57, v57
    v_fmac_f32 v65, v58, v58
    v_fmac_f32 v65, v59, v59
    v_fmac_f32 v65, v60, v60
    v_fmac_f32 v65, v61, v61
    v_fmac_f32 v65, v62, v62
    v_fmac_f32 v65, v63, v63
    s_waitcnt vmcnt(2)
    s_add_u32 s69, s69, 8192
    buffer_load_dwordx4 v[152:155], v96, s[44:47], s69 offen
    s_nop 1
    v_add_f32_dpp v65, v65, v65 quad_perm:[1,0,3,2] row_mask:0xf bank_mask:0xf
    s_nop 1
    v_add_f32_dpp v65, v65, v65 quad_perm:[2,3,0,1] row_mask:0xf bank_mask:0xf
    s_nop 1
    v_add_f32_dpp v65, v65, v65 row_half_mirror row_mask:0xf bank_mask:0xf
    s_nop 1
    v_add_f32_dpp v65, v65, v65 row_mirror row_mask:0xf bank_mask:0xf
    s_nop 1
    v_readlane_b32 s72, v65, 0
    v_readlane_b32 s73, v65, 16
    v_readlane_b32 s74, v65, 32
    v_readlane_b32 s75, v65, 48
    s_nop 1
    v_mov_b32 v65, s72
    v_add_f32 v65, s73, v65
    v_add_f32 v65, s74, v65
    v_add_f32 v65, s75, v65
    s_waitcnt vmcnt(2)
    s_add_u32 s69, s69, 8192
    buffer_load_dwordx4 v[156:159], v96, s[44:47], s69 offen
    v_mov_b32 v66, 0x3727c5ac
    v_fmac_f32 v66, 0x3b000000, v65
    v_sqrt_f32 v66, v66
    s_nop 0
    v_rcp_f32 v66, v66
    s_nop 0
    v_mul_f32 v56, v56, v66
    v_mul_f32 v57, v57, v66
    v_mul_f32 v58, v58, v66
    v_mul_f32 v59, v59, v66
    v_mul_f32 v60, v60, v66
    v_mul_f32 v61, v61, v66
    v_mul_f32 v62, v62, v66
    v_mul_f32 v63, v63, v66
    s_waitcnt vmcnt(2)
    s_add_u32 s69, s67, 2
    s_and_b32 s69, s69, 7
    s_lshl_b32 s69, s69, 15
    s_add_u32 s69, s69, s68
    buffer_load_dwordx4 v[160:163], v96, s[44:47], s69 offen
    v_cvt_pk_bf16_f32 v67, v56, v56
    v_and_b32 v67, 0xffff0000, v67
    v_sub_f32 v68, v56, v67
    v_cvt_pk_bf16_f32 v72, v67, v68
    v_cvt_pk_bf16_f32 v67, v57, v57
    v_and_b32 v67, 0xffff0000, v67
    v_sub_f32 v68, v57, v67
    v_cvt_pk_bf16_f32 v73, v67, v68
    v_cvt_pk_bf16_f32 v67, v58, v58
    v_and_b32 v67, 0xffff0000, v67
    v_sub_f32 v68, v58, v67
    v_cvt_pk_bf16_f32 v74, v67, v68
    v_cvt_pk_bf16_f32 v67, v59, v59
    v_and_b32 v67, 0xffff0000, v67
    v_sub_f32 v68, v59, v67
    v_cvt_pk_bf16_f32 v75, v67, v68
    s_waitcnt vmcnt(2)
    s_add_u32 s69, s69, 8192
    buffer_load_dwordx4 v[164:167], v96, s[44:47], s69 offen
    v_cvt_pk_bf16_f32 v67, v60, v60
    v_and_b32 v67, 0xffff0000, v67
    v_sub_f32 v68, v60, v67
    v_cvt_pk_bf16_f32 v76, v67, v68
    v_cvt_pk_bf16_f32 v67, v61, v61
    v_and_b32 v67, 0xffff0000, v67
    v_sub_f32 v68, v61, v67
    v_cvt_pk_bf16_f32 v77, v67, v68
    v_cvt_pk_bf16_f32 v67, v62, v62
    v_and_b32 v67, 0xffff0000, v67
    v_sub_f32 v68, v62, v67
    v_cvt_pk_bf16_f32 v78, v67, v68
    v_cvt_pk_bf16_f32 v67, v63, v63
    v_and_b32 v67, 0xffff0000, v67
    v_sub_f32 v68, v63, v67
    v_cvt_pk_bf16_f32 v79, v67, v68
    s_waitcnt vmcnt(2)
    s_add_u32 s69, s69, 8192
    buffer_load_dwordx4 v[168:171], v96, s[44:47], s69 offen
    s_lshl_b32 s72, s66, 11
    v_lshlrev_b32 v49, 5, v0
    v_add_u32 v49, s72, v49
    ds_write_b128 v49, v[72:75] offset:16640
    ds_write_b128 v49, v[76:79] offset:16656
    s_mul_i32 s72, s66, 2560
    v_lshlrev_b32 v49, 7, v3
    v_add_u32 v49, s72, v49
    s_waitcnt vmcnt(2)
    s_add_u32 s69, s69, 8192
    buffer_load_dwordx4 v[172:175], v96, s[44:47], s69 offen
    s_waitcnt lgkmcnt(0)
    s_add_u32 s72, s67, 0
    s_and_b32 s72, s72, 7
    s_lshl_b32 s72, s72, 4
    v_add_u32 v50, s72, v49
    ds_read_b128 v[16:19], v50 offset:16640
    s_add_u32 s72, s67, 1
    s_and_b32 s72, s72, 7
    s_lshl_b32 s72, s72, 4
    v_add_u32 v50, s72, v49
    ds_read_b128 v[20:23], v50 offset:16640
    s_add_u32 s72, s67, 2
    s_and_b32 s72, s72, 7
    s_lshl_b32 s72, s72, 4
    v_add_u32 v50, s72, v49
    ds_read_b128 v[24:27], v50 offset:16640
    s_add_u32 s72, s67, 3
    s_and_b32 s72, s72, 7
    s_lshl_b32 s72, s72, 4
    v_add_u32 v50, s72, v49
    ds_read_b128 v[28:31], v50 offset:16640
    s_add_u32 s72, s67, 4
    s_and_b32 s72, s72, 7
    s_lshl_b32 s72, s72, 4
    v_add_u32 v50, s72, v49
    ds_read_b128 v[32:35], v50 offset:16640
    s_add_u32 s72, s67, 5
    s_and_b32 s72, s72, 7
    s_lshl_b32 s72, s72, 4
    v_add_u32 v50, s72, v49
    ds_read_b128 v[36:39], v50 offset:16640
    s_add_u32 s72, s67, 6
    s_and_b32 s72, s72, 7
    s_lshl_b32 s72, s72, 4
    v_add_u32 v50, s72, v49
    ds_read_b128 v[40:43], v50 offset:16640
    s_add_u32 s72, s67, 7
    s_and_b32 s72, s72, 7
    s_lshl_b32 s72, s72, 4
    v_add_u32 v50, s72, v49
    ds_read_b128 v[44:47], v50 offset:16640
    s_waitcnt vmcnt(2)
    s_add_u32 s69, s67, 3
    s_and_b32 s69, s69, 7
    s_lshl_b32 s69, s69, 15
    s_add_u32 s69, s69, s68
    buffer_load_dwordx4 v[176:179], v96, s[44:47], s69 offen
    s_waitcnt lgkmcnt(0)
    s_waitcnt vmcnt(2)
    s_add_u32 s69, s69, 8192
    buffer_load_dwordx4 v[180:183], v96, s[44:47], s69 offen
    v_perm_b32 v8, v16, v16, v4
    v_perm_b32 v9, v16, v16, v5
    v_perm_b32 v10, v16, v16, v6
    v_perm_b32 v11, v16, v16, v7
    s_nop 1
    v_mfma_f32_16x16x32_bf16 v[12:15], v[128:131], v[8:11], 0
    v_perm_b32 v8, v17, v17, v4
    v_perm_b32 v9, v17, v17, v5
    v_perm_b32 v10, v17, v17, v6
    v_perm_b32 v11, v17, v17, v7
    s_nop 1
    v_mfma_f32_16x16x32_bf16 v[12:15], v[132:135], v[8:11], v[12:15]
    v_perm_b32 v8, v18, v18, v4
    v_perm_b32 v9, v18, v18, v5
    v_perm_b32 v10, v18, v18, v6
    v_perm_b32 v11, v18, v18, v7
    s_nop 1
    v_mfma_f32_16x16x32_bf16 v[12:15], v[136:139], v[8:11], v[12:15]
    s_waitcnt vmcnt(2)
    s_add_u32 s69, s69, 8192
    buffer_load_dwordx4 v[184:187], v96, s[44:47], s69 offen
    v_perm_b32 v8, v19, v19, v4
    v_perm_b32 v9, v19, v19, v5
    v_perm_b32 v10, v19, v19, v6
    v_perm_b32 v11, v19, v19, v7
    s_nop 1
    v_mfma_f32_16x16x32_bf16 v[12:15], v[140:143], v[8:11], v[12:15]
    v_perm_b32 v8, v20, v20, v4
    v_perm_b32 v9, v20, v20, v5
    v_perm_b32 v10, v20, v20, v6
    v_perm_b32 v11, v20, v20, v7
    s_nop 1
    v_mfma_f32_16x16x32_bf16 v[12:15], v[144:147], v[8:11], v[12:15]
    v_perm_b32 v8, v21, v21, v4
    v_perm_b32 v9, v21, v21, v5
    v_perm_b32 v10, v21, v21, v6
    v_perm_b32 v11, v21, v21, v7
    s_nop 1
    v_mfma_f32_16x16x32_bf16 v[12:15], v[148:151], v[8:11], v[12:15]
    s_waitcnt vmcnt(2)
    s_add_u32 s69, s69, 8192
    buffer_load_dwordx4 v[188:191], v96, s[44:47], s69 offen
    v_perm_b32 v8, v22, v22, v4
    v_perm_b32 v9, v22, v22, v5
    v_perm_b32 v10, v22, v22, v6
    v_perm_b32 v11, v22, v22, v7
    s_nop 1
    v_mfma_f32_16x16x32_bf16 v[12:15], v[152:155], v[8:11], v[12:15]
    v_perm_b32 v8, v23, v23, v4
    v_perm_b32 v9, v23, v23, v5
    v_perm_b32 v10, v23, v23, v6
    v_perm_b32 v11, v23, v23, v7
    s_nop 1
    v_mfma_f32_16x16x32_bf16 v[12:15], v[156:159], v[8:11], v[12:15]
    v_perm_b32 v8, v24, v24, v4
    v_perm_b32 v9, v24, v24, v5
    v_perm_b32 v10, v24, v24, v6
    v_perm_b32 v11, v24, v24, v7
    s_nop 1
    v_mfma_f32_16x16x32_bf16 v[12:15], v[160:163], v[8:11], v[12:15]
    s_waitcnt vmcnt(2)
    s_add_u32 s69, s67, 4
    s_and_b32 s69, s69, 7
    s_lshl_b32 s69, s69, 15
    s_add_u32 s69, s69, s68
    buffer_load_dwordx4 v[192:195], v96, s[44:47], s69 offen
    v_perm_b32 v8, v25, v25, v4
    v_perm_b32 v9, v25, v25, v5
    v_perm_b32 v10, v25, v25, v6
    v_perm_b32 v11, v25, v25, v7
    s_nop 1
    v_mfma_f32_16x16x32_bf16 v[12:15], v[164:167], v[8:11], v[12:15]
    v_perm_b32 v8, v26, v26, v4
    v_perm_b32 v9, v26, v26, v5
    v_perm_b32 v10, v26, v26, v6
    v_perm_b32 v11, v26, v26, v7
    s_nop 1
    v_mfma_f32_16x16x32_bf16 v[12:15], v[168:171], v[8:11], v[12:15]
    v_perm_b32 v8, v27, v27, v4
    v_perm_b32 v9, v27, v27, v5
    v_perm_b32 v10, v27, v27, v6
    v_perm_b32 v11, v27, v27, v7
    s_nop 1
    v_mfma_f32_16x16x32_bf16 v[12:15], v[172:175], v[8:11], v[12:15]
    s_waitcnt vmcnt(2)
    s_add_u32 s69, s69, 8192
    buffer_load_dwordx4 v[196:199], v96, s[44:47], s69 offen
    v_perm_b32 v8, v28, v28, v4
    v_perm_b32 v9, v28, v28, v5
    v_perm_b32 v10, v28, v28, v6
    v_perm_b32 v11, v28, v28, v7
    s_nop 1
    v_mfma_f32_16x16x32_bf16 v[12:15], v[176:179], v[8:11], v[12:15]
    v_perm_b32 v8, v29, v29, v4
    v_perm_b32 v9, v29, v29, v5
    v_perm_b32 v10, v29, v29, v6
    v_perm_b32 v11, v29, v29, v7
    s_nop 1
    v_mfma_f32_16x16x32_bf16 v[12:15], v[180:183], v[8:11], v[12:15]
    v_perm_b32 v8, v30, v30, v4
    v_perm_b32 v9, v30, v30, v5
    v_perm_b32 v10, v30, v30, v6
    v_perm_b32 v11, v30, v30, v7
    s_nop 1
    v_mfma_f32_16x16x32_bf16 v[12:15], v[184:187], v[8:11], v[12:15]
    s_waitcnt vmcnt(2)
    s_add_u32 s69, s69, 8192
    buffer_load_dwordx4 v[200:203], v96, s[44:47], s69 offen
    v_perm_b32 v8, v31, v31, v4
    v_perm_b32 v9, v31, v31, v5
    v_perm_b32 v10, v31, v31, v6
    v_perm_b32 v11, v31, v31, v7
    s_nop 1
    v_mfma_f32_16x16x32_bf16 v[12:15], v[188:191], v[8:11], v[12:15]
    s_waitcnt vmcnt(2)
    s_add_u32 s69, s69, 8192
    buffer_load_dwordx4 v[204:207], v96, s[44:47], s69 offen
    v_perm_b32 v8, v32, v32, v4
    v_perm_b32 v9, v32, v32, v5
    v_perm_b32 v10, v32, v32, v6
    v_perm_b32 v11, v32, v32, v7
    s_nop 1
    v_mfma_f32_16x16x32_bf16 v[12:15], v[192:195], v[8:11], v[12:15]
    s_waitcnt vmcnt(2)
    s_add_u32 s69, s67, 5
    s_and_b32 s69, s69, 7
    s_lshl_b32 s69, s69, 15
    s_add_u32 s69, s69, s68
    buffer_load_dwordx4 v[208:211], v96, s[44:47], s69 offen
    v_perm_b32 v8, v33, v33, v4
    v_perm_b32 v9, v33, v33, v5
    v_perm_b32 v10, v33, v33, v6
    v_perm_b32 v11, v33, v33, v7
    s_nop 1
    v_mfma_f32_16x16x32_bf16 v[12:15], v[196:199], v[8:11], v[12:15]
    s_waitcnt vmcnt(2)
    s_add_u32 s69, s69, 8192
    buffer_load_dwordx4 v[212:215], v96, s[44:47], s69 offen
    v_perm_b32 v8, v34, v34, v4
    v_perm_b32 v9, v34, v34, v5
    v_perm_b32 v10, v34, v34, v6
    v_perm_b32 v11, v34, v34, v7
    s_nop 1
    v_mfma_f32_16x16x32_bf16 v[12:15], v[200:203], v[8:11], v[12:15]
    s_waitcnt vmcnt(2)
    s_add_u32 s69, s69, 8192
    buffer_load_dwordx4 v[216:219], v96, s[44:47], s69 offen
    v_perm_b32 v8, v35, v35, v4
    v_perm_b32 v9, v35, v35, v5
    v_perm_b32 v10, v35, v35, v6
    v_perm_b32 v11, v35, v35, v7
    s_nop 1
    v_mfma_f32_16x16x32_bf16 v[12:15], v[204:207], v[8:11], v[12:15]
    s_waitcnt vmcnt(2)
    s_add_u32 s69, s69, 8192
    buffer_load_dwordx4 v[220:223], v96, s[44:47], s69 offen
    v_perm_b32 v8, v36, v36, v4
    v_perm_b32 v9, v36, v36, v5
    v_perm_b32 v10, v36, v36, v6
    v_perm_b32 v11, v36, v36, v7
    s_nop 1
    v_mfma_f32_16x16x32_bf16 v[12:15], v[208:211], v[8:11], v[12:15]
    s_waitcnt vmcnt(2)
    s_add_u32 s69, s67, 6
    s_and_b32 s69, s69, 7
    s_lshl_b32 s69, s69, 15
    s_add_u32 s69, s69, s68
    buffer_load_dwordx4 v[224:227], v96, s[44:47], s69 offen
    v_perm_b32 v8, v37, v37, v4
    v_perm_b32 v9, v37, v37, v5
    v_perm_b32 v10, v37, v37, v6
    v_perm_b32 v11, v37, v37, v7
    s_nop 1
    v_mfma_f32_16x16x32_bf16 v[12:15], v[212:215], v[8:11], v[12:15]
    s_waitcnt vmcnt(2)
    s_add_u32 s69, s69, 8192
    buffer_load_dwordx4 v[228:231], v96, s[44:47], s69 offen
    v_perm_b32 v8, v38, v38, v4
    v_perm_b32 v9, v38, v38, v5
    v_perm_b32 v10, v38, v38, v6
    v_perm_b32 v11, v38, v38, v7
    s_nop 1
    v_mfma_f32_16x16x32_bf16 v[12:15], v[216:219], v[8:11], v[12:15]
    s_waitcnt vmcnt(2)
    s_add_u32 s69, s69, 8192
    buffer_load_dwordx4 v[232:235], v96, s[44:47], s69 offen
    v_perm_b32 v8, v39, v39, v4
    v_perm_b32 v9, v39, v39, v5
    v_perm_b32 v10, v39, v39, v6
    v_perm_b32 v11, v39, v39, v7
    s_nop 1
    v_mfma_f32_16x16x32_bf16 v[12:15], v[220:223], v[8:11], v[12:15]
    s_waitcnt vmcnt(2)
    s_add_u32 s69, s69, 8192
    buffer_load_dwordx4 v[236:239], v96, s[44:47], s69 offen
    v_perm_b32 v8, v40, v40, v4
    v_perm_b32 v9, v40, v40, v5
    v_perm_b32 v10, v40, v40, v6
    v_perm_b32 v11, v40, v40, v7
    s_nop 1
    v_mfma_f32_16x16x32_bf16 v[12:15], v[224:227], v[8:11], v[12:15]
    s_waitcnt vmcnt(2)
    s_add_u32 s69, s67, 7
    s_and_b32 s69, s69, 7
    s_lshl_b32 s69, s69, 15
    s_add_u32 s69, s69, s68
    buffer_load_dwordx4 v[240:243], v96, s[44:47], s69 offen
    v_perm_b32 v8, v41, v41, v4
    v_perm_b32 v9, v41, v41, v5
    v_perm_b32 v10, v41, v41, v6
    v_perm_b32 v11, v41, v41, v7
    s_nop 1
    v_mfma_f32_16x16x32_bf16 v[12:15], v[228:231], v[8:11], v[12:15]
    s_waitcnt vmcnt(2)
    s_add_u32 s69, s69, 8192
    buffer_load_dwordx4 v[244:247], v96, s[44:47], s69 offen
    v_perm_b32 v8, v42, v42, v4
    v_perm_b32 v9, v42, v42, v5
    v_perm_b32 v10, v42, v42, v6
    v_perm_b32 v11, v42, v42, v7
    s_nop 1
    v_mfma_f32_16x16x32_bf16 v[12:15], v[232:235], v[8:11], v[12:15]
    s_waitcnt vmcnt(2)
    s_add_u32 s69, s69, 8192
    buffer_load_dwordx4 v[248:251], v96, s[44:47], s69 offen
    v_perm_b32 v8, v43, v43, v4
    v_perm_b32 v9, v43, v43, v5
    v_perm_b32 v10, v43, v43, v6
    v_perm_b32 v11, v43, v43, v7
    s_nop 1
    v_mfma_f32_16x16x32_bf16 v[12:15], v[236:239], v[8:11], v[12:15]
    s_waitcnt vmcnt(2)
    s_add_u32 s69, s69, 8192
    buffer_load_dwordx4 v[252:255], v96, s[44:47], s69 offen
    v_perm_b32 v8, v44, v44, v4
    v_perm_b32 v9, v44, v44, v5
    v_perm_b32 v10, v44, v44, v6
    v_perm_b32 v11, v44, v44, v7
    s_nop 1
    v_mfma_f32_16x16x32_bf16 v[12:15], v[240:243], v[8:11], v[12:15]
    s_waitcnt vmcnt(2)
    v_perm_b32 v8, v45, v45, v4
    v_perm_b32 v9, v45, v45, v5
    v_perm_b32 v10, v45, v45, v6
    v_perm_b32 v11, v45, v45, v7
    s_nop 1
    v_mfma_f32_16x16x32_bf16 v[12:15], v[244:247], v[8:11], v[12:15]
    s_waitcnt vmcnt(1)
    v_perm_b32 v8, v46, v46, v4
    v_perm_b32 v9, v46, v46, v5
    v_perm_b32 v10, v46, v46, v6
    v_perm_b32 v11, v46, v46, v7
    s_nop 1
    v_mfma_f32_16x16x32_bf16 v[12:15], v[248:251], v[8:11], v[12:15]
    s_waitcnt vmcnt(0)
    v_perm_b32 v8, v47, v47, v4
    v_perm_b32 v9, v47, v47, v5
    v_perm_b32 v10, v47, v47, v6
    v_perm_b32 v11, v47, v47, v7
    s_nop 1
    v_mfma_f32_16x16x32_bf16 v[12:15], v[252:255], v[8:11], v[12:15]
    s_lshl_b32 s68, s66, 9
    v_add_u32 v48, s68, v98
    s_nop 7
    v_add_f32_dpp v12, v12, v12 row_ror:8 row_mask:0xf bank_mask:0xf
    v_add_f32_dpp v13, v13, v13 row_ror:8 row_mask:0xf bank_mask:0xf
    v_add_f32_dpp v14, v14, v14 row_ror:8 row_mask:0xf bank_mask:0xf
    v_add_f32_dpp v15, v15, v15 row_ror:8 row_mask:0xf bank_mask:0xf
    ds_write_b32 v48, v12 offset:24832
    ds_write_b32 v48, v13 offset:24864
    ds_write_b32 v48, v14 offset:24896
    ds_write_b32 v48, v15 offset:24928
    s_waitcnt lgkmcnt(0)
    s_barrier
    s_cmp_lg_u32 s66, 1
    s_cbranch_scc1 L_h_noinit
    s_cmp_lg_u32 s2, 0
    s_cbranch_scc1 L_h_noinit
    v_mov_b32 v52, 0
    v_mov_b32 v53, 0
    v_mov_b32 v54, 0
    v_mov_b32 v55, 0
    v_lshlrev_b32 v48, 4, v0
    s_mov_b32 s68, 19
L_zero:
    global_store_dwordx4 v48, v[52:55], s[30:31] sc0 sc1
    global_store_dwordx4 v48, v[52:55], s[30:31] offset:1024 sc0 sc1
    v_add_u32 v48, 2048, v48
    s_sub_u32 s68, s68, 1
    s_cmp_lg_u32 s68, 0
    s_cbranch_scc1 L_zero
    s_waitcnt vmcnt(0)
    v_lshlrev_b32 v48, 2, v0
    v_add_u32 v48, 32, v48
    v_mov_b32 v49, 8
    v_mov_b32 v50, 1
    v_cmp_lt_u32 vcc, 7, v0
    s_nop 1
    v_cndmask_b32 v49, v49, v50, vcc
    s_mov_b64 exec, 0x1ff
    global_atomic_add v48, v49, s[28:29]
    s_mov_b64 exec, -1
L_h_noinit:
    s_bitcmp1_b32 s32, 3
    s_cbranch_scc1 L_h_noffn
    s_and_b32 s81, s32, 7
    s_lshr_b32 s68, s32, 4
    s_lshl_b32 s68, s68, 3
    s_or_b32 s81, s81, s68
    s_cmp_ge_u32 s81, 14
    s_cbranch_scc1 L_h_noffn
    v_mul_u32_u24 v96, 28672, v3
    v_lshl_add_u32 v96, v2, 4, v96
    s_lshl_b32 s76, s34, 2
    s_add_u32 s76, s76, s66
    s_lshl_b32 s68, s66, 11
    s_lshl_b32 s69, s76, 7
    s_add_u32 s68, s68, s69
    v_lshlrev_b32 v49, 5, v3
    v_add_u32 v49, s68, v49
    ds_read_b128 v[16:19], v49 offset:16640
    ds_read_b128 v[20:23], v49 offset:16656
    s_mov_b32 s44, s20
    s_mov_b32 s45, s21
    s_mov_b32 s46, 1835008
    s_mul_i32 s68, s76, 114688
    s_lshl_b32 s69, s81, 8
    s_add_u32 s68, s68, s69
    buffer_load_dwordx4 v[128:131], v96, s[44:47], s68 offen
    s_add_u32 s68, s68, 3584
    s_waitcnt lgkmcnt(0)
    s_waitcnt vmcnt(0)
    buffer_load_dwordx4 v[132:135], v96, s[44:47], s68 offen
    s_add_u32 s68, s68, 3584
    v_perm_b32 v8, v16, v16, v4
    v_perm_b32 v9, v16, v16, v5
    v_perm_b32 v10, v16, v16, v6
    v_perm_b32 v11, v16, v16, v7
    s_nop 1
    v_mfma_f32_16x16x32_bf16 v[12:15], v[128:131], v[8:11], 0
    s_waitcnt vmcnt(0)
    buffer_load_dwordx4 v[136:139], v96, s[44:47], s68 offen
    s_add_u32 s68, s68, 3584
    v_perm_b32 v8, v17, v17, v4
    v_perm_b32 v9, v17, v17, v5
    v_perm_b32 v10, v17, v17, v6
    v_perm_b32 v11, v17, v17, v7
    s_nop 1
    v_mfma_f32_16x16x32_bf16 v[12:15], v[132:135], v[8:11], v[12:15]
    s_waitcnt vmcnt(0)
    buffer_load_dwordx4 v[140:143], v96, s[44:47], s68 offen
    s_add_u32 s68, s68, 3584
    v_perm_b32 v8, v18, v18, v4
    v_perm_b32 v9, v18, v18, v5
    v_perm_b32 v10, v18, v18, v6
    v_perm_b32 v11, v18, v18, v7
    s_nop 1
    v_mfma_f32_16x16x32_bf16 v[12:15], v[136:139], v[8:11], v[12:15]
    s_waitcnt vmcnt(0)
    buffer_load_dwordx4 v[144:147], v96, s[44:47], s68 offen
    s_add_u32 s68, s68, 3584
    v_perm_b32 v8, v19, v19, v4
    v_perm_b32 v9, v19, v19, v5
    v_perm_b32 v10, v19, v19, v6
    v_perm_b32 v11, v19, v19, v7
    s_nop 1
    v_mfma_f32_16x16x32_bf16 v[12:15], v[140:143], v[8:11], v[12:15]
    s_waitcnt vmcnt(0)
    buffer_load_dwordx4 v[148:151], v96, s[44:47], s68 offen
    s_add_u32 s68, s68, 3584
    v_perm_b32 v8, v20, v20, v4
    v_perm_b32 v9, v20, v20, v5
    v_perm_b32 v10, v20, v20, v6
    v_perm_b32 v11, v20, v20, v7
    s_nop 1
    v_mfma_f32_16x16x32_bf16 v[12:15], v[144:147], v[8:11], v[12:15]
    s_waitcnt vmcnt(0)
    buffer_load_dwordx4 v[152:155], v96, s[44:47], s68 offen
    s_add_u32 s68, s68, 3584
    v_perm_b32 v8, v21, v21, v4
    v_perm_b32 v9, v21, v21, v5
    v_perm_b32 v10, v21, v21, v6
    v_perm_b32 v11, v21, v21, v7
    s_nop 1
    v_mfma_f32_16x16x32_bf16 v[12:15], v[148:151], v[8:11], v[12:15]
    s_waitcnt vmcnt(0)
    buffer_load_dwordx4 v[156:159], v96, s[44:47], s68 offen
    s_add_u32 s68, s68, 3584
    v_perm_b32 v8, v22, v22, v4
    v_perm_b32 v9, v22, v22, v5
    v_perm_b32 v10, v22, v22, v6
    v_perm_b32 v11, v22, v22, v7
    s_nop 1
    v_mfma_f32_16x16x32_bf16 v[12:15], v[152:155], v[8:11], v[12:15]
    s_waitcnt vmcnt(0)
    v_perm_b32 v8, v23, v23, v4
    v_perm_b32 v9, v23, v23, v5
    v_perm_b32 v10, v23, v23, v6
    v_perm_b32 v11, v23, v23, v7
    s_nop 1
    v_mfma_f32_16x16x32_bf16 v[12:15], v[156:159], v[8:11], v[12:15]
    s_nop 7
    v_add_f32_dpp v12, v12, v12 row_ror:8 row_mask:0xf bank_mask:0xf
    v_add_f32_dpp v13, v13, v13 row_ror:8 row_mask:0xf bank_mask:0xf
    v_add_f32_dpp v14, v14, v14 row_ror:8 row_mask:0xf bank_mask:0xf
    v_add_f32_dpp v15, v15, v15 row_ror:8 row_mask:0xf bank_mask:0xf
    s_mov_b32 s74, 0x00ff00ff
    s_mov_b32 s75, 0x00ff00ff
    s_mov_b64 exec, s[74:75]
    ds_add_f32 v98, v12 offset:27392
    ds_add_f32 v98, v13 offset:27424
    ds_add_f32 v98, v14 offset:27456
    ds_add_f32 v98, v15 offset:27488
    s_mov_b64 exec, -1
    s_mov_b32 s44, s22
    s_mov_b32 s45, s23
    s_mov_b32 s46, 1835008
    s_mul_i32 s68, s76, 114688
    s_lshl_b32 s69, s81, 8
    s_add_u32 s68, s68, s69
    buffer_load_dwordx4 v[128:131], v96, s[44:47], s68 offen
    s_add_u32 s68, s68, 3584
    s_waitcnt lgkmcnt(0)
    s_waitcnt vmcnt(0)
    buffer_load_dwordx4 v[132:135], v96, s[44:47], s68 offen
    s_add_u32 s68, s68, 3584
    v_perm_b32 v8, v16, v16, v4
    v_perm_b32 v9, v16, v16, v5
    v_perm_b32 v10, v16, v16, v6
    v_perm_b32 v11, v16, v16, v7
    s_nop 1
    v_mfma_f32_16x16x32_bf16 v[12:15], v[128:131], v[8:11], 0
    s_waitcnt vmcnt(0)
    buffer_load_dwordx4 v[136:139], v96, s[44:47], s68 offen
    s_add_u32 s68, s68, 3584
    v_perm_b32 v8, v17, v17, v4
    v_perm_b32 v9, v17, v17, v5
    v_perm_b32 v10, v17, v17, v6
    v_perm_b32 v11, v17, v17, v7
    s_nop 1
    v_mfma_f32_16x16x32_bf16 v[12:15], v[132:135], v[8:11], v[12:15]
    s_waitcnt vmcnt(0)
    buffer_load_dwordx4 v[140:143], v96, s[44:47], s68 offen
    s_add_u32 s68, s68, 3584
    v_perm_b32 v8, v18, v18, v4
    v_perm_b32 v9, v18, v18, v5
    v_perm_b32 v10, v18, v18, v6
    v_perm_b32 v11, v18, v18, v7
    s_nop 1
    v_mfma_f32_16x16x32_bf16 v[12:15], v[136:139], v[8:11], v[12:15]
    s_waitcnt vmcnt(0)
    buffer_load_dwordx4 v[144:147], v96, s[44:47], s68 offen
    s_add_u32 s68, s68, 3584
    v_perm_b32 v8, v19, v19, v4
    v_perm_b32 v9, v19, v19, v5
    v_perm_b32 v10, v19, v19, v6
    v_perm_b32 v11, v19, v19, v7
    s_nop 1
    v_mfma_f32_16x16x32_bf16 v[12:15], v[140:143], v[8:11], v[12:15]
    s_waitcnt vmcnt(0)
    buffer_load_dwordx4 v[148:151], v96, s[44:47], s68 offen
    s_add_u32 s68, s68, 3584
    v_perm_b32 v8, v20, v20, v4
    v_perm_b32 v9, v20, v20, v5
    v_perm_b32 v10, v20, v20, v6
    v_perm_b32 v11, v20, v20, v7
    s_nop 1
    v_mfma_f32_16x16x32_bf16 v[12:15], v[144:147], v[8:11], v[12:15]
    s_waitcnt vmcnt(0)
    buffer_load_dwordx4 v[152:155], v96, s[44:47], s68 offen
    s_add_u32 s68, s68, 3584
    v_perm_b32 v8, v21, v21, v4
    v_perm_b32 v9, v21, v21, v5
    v_perm_b32 v10, v21, v21, v6
    v_perm_b32 v11, v21, v21, v7
    s_nop 1
    v_mfma_f32_16x16x32_bf16 v[12:15], v[148:151], v[8:11], v[12:15]
    s_waitcnt vmcnt(0)
    buffer_load_dwordx4 v[156:159], v96, s[44:47], s68 offen
    s_add_u32 s68, s68, 3584
    v_perm_b32 v8, v22, v22, v4
    v_perm_b32 v9, v22, v22, v5
    v_perm_b32 v10, v22, v22, v6
    v_perm_b32 v11, v22, v22, v7
    s_nop 1
    v_mfma_f32_16x16x32_bf16 v[12:15], v[152:155], v[8:11], v[12:15]
    s_waitcnt vmcnt(0)
    v_perm_b32 v8, v23, v23, v4
    v_perm_b32 v9, v23, v23, v5
    v_perm_b32 v10, v23, v23, v6
    v_perm_b32 v11, v23, v23, v7
    s_nop 1
    v_mfma_f32_16x16x32_bf16 v[12:15], v[156:159], v[8:11], v[12:15]
    s_nop 7
    v_add_f32_dpp v12, v12, v12 row_ror:8 row_mask:0xf bank_mask:0xf
    v_add_f32_dpp v13, v13, v13 row_ror:8 row_mask:0xf bank_mask:0xf
    v_add_f32_dpp v14, v14, v14 row_ror:8 row_mask:0xf bank_mask:0xf
    v_add_f32_dpp v15, v15, v15 row_ror:8 row_mask:0xf bank_mask:0xf
    s_mov_b32 s74, 0x00ff00ff
    s_mov_b32 s75, 0x00ff00ff
    s_mov_b64 exec, s[74:75]
    ds_add_f32 v98, v12 offset:27904
    ds_add_f32 v98, v13 offset:27936
    ds_add_f32 v98, v14 offset:27968
    ds_add_f32 v98, v15 offset:28000
    s_mov_b64 exec, -1
    s_waitcnt lgkmcnt(0)
    v_mov_b32 v48, 0
    v_mov_b32 v49, 1
    s_mov_b64 exec, 1
    ds_add_u32 v48, v49 offset:26976
    s_mov_b64 exec, -1
L_ffn_sync:
    s_sleep 4
    ds_read_b32 v49, v48 offset:26976
    s_waitcnt lgkmcnt(0)
    v_cmp_ne_u32 vcc, 4, v49
    s_cbranch_vccnz L_ffn_sync
    s_lshl_b32 s68, s66, 8
    v_lshlrev_b32 v50, 2, v0
    v_add_u32 v50, s68, v50
    ds_read_b32 v51, v50 offset:27392
    s_mul_i32 s77, s33, 14
    s_add_u32 s77, s77, s81
    s_lshl_b32 s69, s77, 12
    s_add_u32 s69, s69, 40960
    s_lshl_b32 s70, s34, 10
    s_add_u32 s70, s70, s69
    v_add_u32 v50, s70, v50
    s_waitcnt lgkmcnt(0)
    global_store_dword v50, v51, s[30:31] sc0 sc1
    v_mov_b32 v52, 0
    v_mov_b32 v49, 1
    s_waitcnt vmcnt(0)
    s_mov_b64 exec, 1
    ds_add_u32 v52, v49 offset:27016
    s_mov_b64 exec, -1
    s_cmp_lg_u32 s66, 0
    s_cbranch_scc1 L_ffn_wait
L_ffn_st:
    s_sleep 4
    ds_read_b32 v49, v52 offset:27016
    s_waitcnt lgkmcnt(0)
    v_cmp_ne_u32 vcc, 4, v49
    s_cbranch_vccnz L_ffn_st
    s_branch L_ffn_z1
L_ffn_z:
    s_sleep 64
L_ffn_z1:
    global_load_dword v49, v52, s[28:29] offset:64 sc0 sc1
    s_waitcnt vmcnt(0)
    v_cmp_eq_u32 vcc, 0, v49
    s_cbranch_vccnz L_ffn_z
    s_lshl_b32 s70, s77, 6
    s_add_u32 s70, s70, 36864
    v_mov_b32 v48, s70
    v_mov_b32 v49, 1
    s_mov_b64 exec, 1
    global_atomic_add v48, v49, s[30:31]
    s_mov_b64 exec, -1
L_ffn_poll:
    s_sleep 120
    global_load_dword v49, v48, s[30:31] sc0 sc1
    s_waitcnt vmcnt(0)
    v_cmp_ne_u32 vcc, 4, v49
    s_cbranch_vccnz L_ffn_poll
    v_lshlrev_b32 v50, 4, v0
    v_add_u32 v51, s69, v50
    global_load_dwordx4 v[56:59], v51, s[30:31] offset:0 sc0 sc1
    global_load_dwordx4 v[60:63], v51, s[30:31] offset:1024 sc0 sc1
    global_load_dwordx4 v[64:67], v51, s[30:31] offset:2048 sc0 sc1
    global_load_dwordx4 v[68:71], v51, s[30:31] offset:3072 sc0 sc1
    s_waitcnt vmcnt(0)
    v_add_f32 v56, v56, v60
    v_add_f32 v57, v57, v61
    v_add_f32 v58, v58, v62
    v_add_f32 v59, v59, v63
    v_add_f32 v56, v56, v64
    v_add_f32 v57, v57, v65
    v_add_f32 v58, v58, v66
    v_add_f32 v59, v59, v67
    v_add_f32 v56, v56, v68
    v_add_f32 v57, v57, v69
    v_add_f32 v58, v58, v70
    v_add_f32 v59, v59, v71
    ds_write_b128 v50, v[56:59] offset:27392
    v_mov_b32 v49, 1
    s_waitcnt lgkmcnt(0)
    ds_write_b32 v52, v49 offset:27012
L_ffn_wait:
    s_sleep 8
    ds_read_b32 v49, v52 offset:27012
    s_waitcnt lgkmcnt(0)
    v_cmp_eq_u32 vcc, 0, v49
    s_cbranch_vccnz L_ffn_wait
    s_lshl_b32 s68, s66, 7
    v_lshlrev_b32 v50, 5, v3
    v_add_u32 v50, s68, v50
    ds_read_b128 v[16:19], v50 offset:27392
    ds_read_b128 v[56:59], v50 offset:27904
    ds_read_b128 v[20:23], v50 offset:27408
    ds_read_b128 v[60:63], v50 offset:27920
    s_waitcnt lgkmcnt(0)
    s_mov_b32 s68, 0xbfb8aa3b
    s_waitcnt vmcnt(0)
    v_mul_f32 v48, s68, v16
    v_exp_f32 v48, v48
    s_nop 0
    v_add_f32 v48, 1.0, v48
    v_rcp_f32 v48, v48
    s_nop 0
    v_mul_f32 v48, v48, v16
    v_mul_f32 v48, v48, v56
    v_cvt_pk_bf16_f32 v49, v48, v48
    v_and_b32 v49, 0xffff0000, v49
    v_sub_f32 v50, v48, v49
    v_cvt_pk_bf16_f32 v16, v49, v50
    v_mul_f32 v48, s68, v17
    v_exp_f32 v48, v48
    s_nop 0
    v_add_f32 v48, 1.0, v48
    v_rcp_f32 v48, v48
    s_nop 0
    v_mul_f32 v48, v48, v17
    v_mul_f32 v48, v48, v57
    v_cvt_pk_bf16_f32 v49, v48, v48
    v_and_b32 v49, 0xffff0000, v49
    v_sub_f32 v50, v48, v49
    v_cvt_pk_bf16_f32 v17, v49, v50
    v_mul_f32 v48, s68, v18
    v_exp_f32 v48, v48
    s_nop 0
    v_add_f32 v48, 1.0, v48
    v_rcp_f32 v48, v48
    s_nop 0
    v_mul_f32 v48, v48, v18
    v_mul_f32 v48, v48, v58
    v_cvt_pk_bf16_f32 v49, v48, v48
    v_and_b32 v49, 0xffff0000, v49
    v_sub_f32 v50, v48, v49
    v_cvt_pk_bf16_f32 v18, v49, v50
    v_mul_f32 v48, s68, v19
    v_exp_f32 v48, v48
    s_nop 0
    v_add_f32 v48, 1.0, v48
    v_rcp_f32 v48, v48
    s_nop 0
    v_mul_f32 v48, v48, v19
    v_mul_f32 v48, v48, v59
    v_cvt_pk_bf16_f32 v49, v48, v48
    v_and_b32 v49, 0xffff0000, v49
    v_sub_f32 v50, v48, v49
    v_cvt_pk_bf16_f32 v19, v49, v50
    v_mul_f32 v48, s68, v20
    v_exp_f32 v48, v48
    s_nop 0
    v_add_f32 v48, 1.0, v48
    v_rcp_f32 v48, v48
    s_nop 0
    v_mul_f32 v48, v48, v20
    v_mul_f32 v48, v48, v60
    v_cvt_pk_bf16_f32 v49, v48, v48
    v_and_b32 v49, 0xffff0000, v49
    v_sub_f32 v50, v48, v49
    v_cvt_pk_bf16_f32 v20, v49, v50
    v_mul_f32 v48, s68, v21
    v_exp_f32 v48, v48
    s_nop 0
    v_add_f32 v48, 1.0, v48
    v_rcp_f32 v48, v48
    s_nop 0
    v_mul_f32 v48, v48, v21
    v_mul_f32 v48, v48, v61
    v_cvt_pk_bf16_f32 v49, v48, v48
    v_and_b32 v49, 0xffff0000, v49
    v_sub_f32 v50, v48, v49
    v_cvt_pk_bf16_f32 v21, v49, v50
    v_mul_f32 v48, s68, v22
    v_exp_f32 v48, v48
    s_nop 0
    v_add_f32 v48, 1.0, v48
    v_rcp_f32 v48, v48
    s_nop 0
    v_mul_f32 v48, v48, v22
    v_mul_f32 v48, v48, v62
    v_cvt_pk_bf16_f32 v49, v48, v48
    v_and_b32 v49, 0xffff0000, v49
    v_sub_f32 v50, v48, v49
    v_cvt_pk_bf16_f32 v22, v49, v50
    v_mul_f32 v48, s68, v23
    v_exp_f32 v48, v48
    s_nop 0
    v_add_f32 v48, 1.0, v48
    v_rcp_f32 v48, v48
    s_nop 0
    v_mul_f32 v48, v48, v23
    v_mul_f32 v48, v48, v63
    v_cvt_pk_bf16_f32 v49, v48, v48
    v_and_b32 v49, 0xffff0000, v49
    v_sub_f32 v50, v48, v49
    v_cvt_pk_bf16_f32 v23, v49, v50
    s_mov_b32 s44, s24
    s_mov_b32 s45, s25
    s_mov_b32 s46, 1835008
    v_lshlrev_b32 v96, 13, v3
    v_lshl_add_u32 v96, v2, 4, v96
    s_lshl_b32 s68, s81, 17
    s_lshl_b32 s70, s66, 15
    s_add_u32 s68, s68, s70
    s_lshl_b32 s70, s34, 8
    s_add_u32 s68, s68, s70
    buffer_load_dwordx4 v[128:131], v96, s[44:47], s68 offen
    s_add_u32 s68, s68, 1024
    s_waitcnt lgkmcnt(0)
    s_waitcnt vmcnt(0)
    buffer_load_dwordx4 v[132:135], v96, s[44:47], s68 offen
    s_add_u32 s68, s68, 1024
    v_perm_b32 v8, v16, v16, v4
    v_perm_b32 v9, v16, v16, v5
    v_perm_b32 v10, v16, v16, v6
    v_perm_b32 v11, v16, v16, v7
    s_nop 1
    v_mfma_f32_16x16x32_bf16 v[12:15], v[128:131], v[8:11], 0
    s_waitcnt vmcnt(0)
    buffer_load_dwordx4 v[136:139], v96, s[44:47], s68 offen
    s_add_u32 s68, s68, 1024
    v_perm_b32 v8, v17, v17, v4
    v_perm_b32 v9, v17, v17, v5
    v_perm_b32 v10, v17, v17, v6
    v_perm_b32 v11, v17, v17, v7
    s_nop 1
    v_mfma_f32_16x16x32_bf16 v[12:15], v[132:135], v[8:11], v[12:15]
    s_waitcnt vmcnt(0)
    buffer_load_dwordx4 v[140:143], v96, s[44:47], s68 offen
    s_add_u32 s68, s68, 1024
    v_perm_b32 v8, v18, v18, v4
    v_perm_b32 v9, v18, v18, v5
    v_perm_b32 v10, v18, v18, v6
    v_perm_b32 v11, v18, v18, v7
    s_nop 1
    v_mfma_f32_16x16x32_bf16 v[12:15], v[136:139], v[8:11], v[12:15]
    s_waitcnt vmcnt(0)
    buffer_load_dwordx4 v[144:147], v96, s[44:47], s68 offen
    s_add_u32 s68, s68, 1024
    v_perm_b32 v8, v19, v19, v4
    v_perm_b32 v9, v19, v19, v5
    v_perm_b32 v10, v19, v19, v6
    v_perm_b32 v11, v19, v19, v7
    s_nop 1
    v_mfma_f32_16x16x32_bf16 v[12:15], v[140:143], v[8:11], v[12:15]
    s_waitcnt vmcnt(0)
    buffer_load_dwordx4 v[148:151], v96, s[44:47], s68 offen
    s_add_u32 s68, s68, 1024
    v_perm_b32 v8, v20, v20, v4
    v_perm_b32 v9, v20, v20, v5
    v_perm_b32 v10, v20, v20, v6
    v_perm_b32 v11, v20, v20, v7
    s_nop 1
    v_mfma_f32_16x16x32_bf16 v[12:15], v[144:147], v[8:11], v[12:15]
    s_waitcnt vmcnt(0)
    buffer_load_dwordx4 v[152:155], v96, s[44:47], s68 offen
    s_add_u32 s68, s68, 1024
    v_perm_b32 v8, v21, v21, v4
    v_perm_b32 v9, v21, v21, v5
    v_perm_b32 v10, v21, v21, v6
    v_perm_b32 v11, v21, v21, v7
    s_nop 1
    v_mfma_f32_16x16x32_bf16 v[12:15], v[148:151], v[8:11], v[12:15]
    s_waitcnt vmcnt(0)
    buffer_load_dwordx4 v[156:159], v96, s[44:47], s68 offen
    s_add_u32 s68, s68, 1024
    v_perm_b32 v8, v22, v22, v4
    v_perm_b32 v9, v22, v22, v5
    v_perm_b32 v10, v22, v22, v6
    v_perm_b32 v11, v22, v22, v7
    s_nop 1
    v_mfma_f32_16x16x32_bf16 v[12:15], v[152:155], v[8:11], v[12:15]
    s_waitcnt vmcnt(0)
    v_perm_b32 v8, v23, v23, v4
    v_perm_b32 v9, v23, v23, v5
    v_perm_b32 v10, v23, v23, v6
    v_perm_b32 v11, v23, v23, v7
    s_nop 1
    v_mfma_f32_16x16x32_bf16 v[12:15], v[156:159], v[8:11], v[12:15]
    s_nop 7
    v_add_f32_dpp v12, v12, v12 row_ror:8 row_mask:0xf bank_mask:0xf
    v_add_f32_dpp v13, v13, v13 row_ror:8 row_mask:0xf bank_mask:0xf
    v_add_f32_dpp v14, v14, v14 row_ror:8 row_mask:0xf bank_mask:0xf
    v_add_f32_dpp v15, v15, v15 row_ror:8 row_mask:0xf bank_mask:0xf
    s_and_b32 s72, s2, 7
    s_lshl_b32 s72, s72, 12
    s_lshl_b32 s73, s33, 11
    s_add_u32 s72, s72, s73
    s_lshl_b32 s73, s34, 9
    s_add_u32 s72, s72, s73
    v_add_u32 v52, s72, v98
    s_mov_b32 s74, 0x00ff00ff
    s_mov_b32 s75, 0x00ff00ff
    s_mov_b64 exec, s[74:75]
    global_atomic_add_f32 v52, v12, s[30:31] offset:0
    global_atomic_add_f32 v52, v13, s[30:31] offset:32
    global_atomic_add_f32 v52, v14, s[30:31] offset:64
    global_atomic_add_f32 v52, v15, s[30:31] offset:96
    s_mov_b64 exec, -1
L_h_noffn:
    s_lshl_b32 s68, s66, 2
    v_mov_b32 v48, s68
L_pb_poll:
    s_sleep 16
    ds_read_b32 v49, v48 offset:26992
    s_waitcnt lgkmcnt(0)
    v_cmp_eq_u32 vcc, 0, v49
    s_cbranch_vccnz L_pb_poll
    s_mov_b32 s44, s16
    s_mov_b32 s45, s17
    s_mov_b32 s46, 0x400000
    v_lshlrev_b32 v96, 10, v3
    v_lshl_add_u32 v96, v2, 4, v96
    s_lshl_b32 s68, s32, 17
    s_lshl_b32 s70, s66, 8
    s_add_u32 s68, s68, s70
    s_lshl_b32 s71, s66, 15
    s_add_u32 s71, s71, 30976
    s_add_u32 m0, s71, 0
    s_nop 0
    buffer_load_dwordx4 v96, s[44:47], s68 offen  lds
    s_add_u32 s68, s68, 4096
    s_add_u32 m0, s71, 1024
    s_nop 0
    buffer_load_dwordx4 v96, s[44:47], s68 offen  lds
    s_add_u32 s68, s68, 4096
    s_add_u32 m0, s71, 2048
    s_nop 0
    buffer_load_dwordx4 v96, s[44:47], s68 offen  lds
    s_add_u32 s68, s68, 4096
    s_waitcnt vmcnt(2)
    s_add_u32 m0, s71, 3072
    s_nop 0
    buffer_load_dwordx4 v96, s[44:47], s68 offen  lds
    s_add_u32 s68, s68, 4096
    s_waitcnt vmcnt(2)
    s_add_u32 m0, s71, 4096
    s_nop 0
    buffer_load_dwordx4 v96, s[44:47], s68 offen  lds
    s_add_u32 s68, s68, 4096
    s_waitcnt vmcnt(2)
    s_add_u32 m0, s71, 5120
    s_nop 0
    buffer_load_dwordx4 v96, s[44:47], s68 offen  lds
    s_add_u32 s68, s68, 4096
    s_waitcnt vmcnt(2)
    s_add_u32 m0, s71, 6144
    s_nop 0
    buffer_load_dwordx4 v96, s[44:47], s68 offen  lds
    s_add_u32 s68, s68, 4096
    s_waitcnt vmcnt(2)
    s_add_u32 m0, s71, 7168
    s_nop 0
    buffer_load_dwordx4 v96, s[44:47], s68 offen  lds
    s_add_u32 s68, s68, 4096
    s_waitcnt vmcnt(2)
    s_add_u32 m0, s71, 8192
    s_nop 0
    buffer_load_dwordx4 v96, s[44:47], s68 offen  lds
    s_add_u32 s68, s68, 4096
    s_waitcnt vmcnt(2)
    s_add_u32 m0, s71, 9216
    s_nop 0
    buffer_load_dwordx4 v96, s[44:47], s68 offen  lds
    s_add_u32 s68, s68, 4096
    s_waitcnt vmcnt(2)
    s_add_u32 m0, s71, 10240
    s_nop 0
    buffer_load_dwordx4 v96, s[44:47], s68 offen  lds
    s_add_u32 s68, s68, 4096
    s_waitcnt vmcnt(2)
    s_add_u32 m0, s71, 11264
    s_nop 0
    buffer_load_dwordx4 v96, s[44:47], s68 offen  lds
    s_add_u32 s68, s68, 4096
    s_waitcnt vmcnt(2)
    s_add_u32 m0, s71, 12288
    s_nop 0
    buffer_load_dwordx4 v96, s[44:47], s68 offen  lds
    s_add_u32 s68, s68, 4096
    s_waitcnt vmcnt(2)
    s_add_u32 m0, s71, 13312
    s_nop 0
    buffer_load_dwordx4 v96, s[44:47], s68 offen  lds
    s_add_u32 s68, s68, 4096
    s_waitcnt vmcnt(2)
    s_add_u32 m0, s71, 14336
    s_nop 0
    buffer_load_dwordx4 v96, s[44:47], s68 offen  lds
    s_add_u32 s68, s68, 4096
    s_waitcnt vmcnt(2)
    s_add_u32 m0, s71, 15360
    s_nop 0
    buffer_load_dwordx4 v96, s[44:47], s68 offen  lds
    s_add_u32 s68, s68, 4096
    s_waitcnt vmcnt(2)
    s_add_u32 m0, s71, 16384
    s_nop 0
    buffer_load_dwordx4 v96, s[44:47], s68 offen  lds
    s_add_u32 s68, s68, 4096
    s_waitcnt vmcnt(2)
    s_add_u32 m0, s71, 17408
    s_nop 0
    buffer_load_dwordx4 v96, s[44:47], s68 offen  lds
    s_add_u32 s68, s68, 4096
    s_waitcnt vmcnt(2)
    s_add_u32 m0, s71, 18432
    s_nop 0
    buffer_load_dwordx4 v96, s[44:47], s68 offen  lds
    s_add_u32 s68, s68, 4096
    s_waitcnt vmcnt(2)
    s_add_u32 m0, s71, 19456
    s_nop 0
    buffer_load_dwordx4 v96, s[44:47], s68 offen  lds
    s_add_u32 s68, s68, 4096
    s_waitcnt vmcnt(2)
    s_add_u32 m0, s71, 20480
    s_nop 0
    buffer_load_dwordx4 v96, s[44:47], s68 offen  lds
    s_add_u32 s68, s68, 4096
    s_waitcnt vmcnt(2)
    s_add_u32 m0, s71, 21504
    s_nop 0
    buffer_load_dwordx4 v96, s[44:47], s68 offen  lds
    s_add_u32 s68, s68, 4096
    s_waitcnt vmcnt(2)
    s_add_u32 m0, s71, 22528
    s_nop 0
    buffer_load_dwordx4 v96, s[44:47], s68 offen  lds
    s_add_u32 s68, s68, 4096
    s_waitcnt vmcnt(2)
    s_add_u32 m0, s71, 23552
    s_nop 0
    buffer_load_dwordx4 v96, s[44:47], s68 offen  lds
    s_add_u32 s68, s68, 4096
    s_waitcnt vmcnt(2)
    s_add_u32 m0, s71, 24576
    s_nop 0
    buffer_load_dwordx4 v96, s[44:47], s68 offen  lds
    s_add_u32 s68, s68, 4096
    s_waitcnt vmcnt(2)
    s_add_u32 m0, s71, 25600
    s_nop 0
    buffer_load_dwordx4 v96, s[44:47], s68 offen  lds
    s_add_u32 s68, s68, 4096
    s_waitcnt vmcnt(2)
    s_add_u32 m0, s71, 26624
    s_nop 0
    buffer_load_dwordx4 v96, s[44:47], s68 offen  lds
    s_add_u32 s68, s68, 4096
    s_waitcnt vmcnt(2)
    s_add_u32 m0, s71, 27648
    s_nop 0
    buffer_load_dwordx4 v96, s[44:47], s68 offen  lds
    s_add_u32 s68, s68, 4096
    s_waitcnt vmcnt(2)
    s_add_u32 m0, s71, 28672
    s_nop 0
    buffer_load_dwordx4 v96, s[44:47], s68 offen  lds
    s_add_u32 s68, s68, 4096
    s_waitcnt vmcnt(2)
    s_add_u32 m0, s71, 29696
    s_nop 0
    buffer_load_dwordx4 v96, s[44:47], s68 offen  lds
    s_add_u32 s68, s68, 4096
    s_waitcnt vmcnt(2)
    s_add_u32 m0, s71, 30720
    s_nop 0
    buffer_load_dwordx4 v96, s[44:47], s68 offen  lds
    s_add_u32 s68, s68, 4096
    s_waitcnt vmcnt(2)
    s_add_u32 m0, s71, 31744
    s_nop 0
    buffer_load_dwordx4 v96, s[44:47], s68 offen  lds
    s_add_u32 s68, s68, 4096
    v_lshrrev_b32 v48, 2, v2
    v_lshlrev_b32 v48, 8, v48
    v_and_b32 v49, 3, v2
    v_lshl_add_u32 v48, v49, 3, v48
    v_lshl_add_u32 v48, v3, 11, v48
    v_add_u32 v48, s71, v48
    s_waitcnt vmcnt(0)
    ds_read_b64_tr_b16 v[128:129], v48 offset:0
    ds_read_b64_tr_b16 v[130:131], v48 offset:1024
    ds_read_b64_tr_b16 v[132:133], v48 offset:8192
    ds_read_b64_tr_b16 v[134:135], v48 offset:9216
    ds_read_b64_tr_b16 v[136:137], v48 offset:16384
    ds_read_b64_tr_b16 v[138:139], v48 offset:17408
    ds_read_b64_tr_b16 v[140:141], v48 offset:24576
    ds_read_b64_tr_b16 v[142:143], v48 offset:25600
    s_waitcnt lgkmcnt(0)
    ds_read_b64_tr_b16 v[144:145], v48 offset:32
    ds_read_b64_tr_b16 v[146:147], v48 offset:1056
    ds_read_b64_tr_b16 v[148:149], v48 offset:8224
    ds_read_b64_tr_b16 v[150:151], v48 offset:9248
    ds_read_b64_tr_b16 v[152:153], v48 offset:16416
    ds_read_b64_tr_b16 v[154:155], v48 offset:17440
    ds_read_b64_tr_b16 v[156:157], v48 offset:24608
    ds_read_b64_tr_b16 v[158:159], v48 offset:25632
    s_waitcnt lgkmcnt(0)
    ds_read_b64_tr_b16 v[160:161], v48 offset:64
    ds_read_b64_tr_b16 v[162:163], v48 offset:1088
    ds_read_b64_tr_b16 v[164:165], v48 offset:8256
    ds_read_b64_tr_b16 v[166:167], v48 offset:9280
    ds_read_b64_tr_b16 v[168:169], v48 offset:16448
    ds_read_b64_tr_b16 v[170:171], v48 offset:17472
    ds_read_b64_tr_b16 v[172:173], v48 offset:24640
    ds_read_b64_tr_b16 v[174:175], v48 offset:25664
    s_waitcnt lgkmcnt(0)
    ds_read_b64_tr_b16 v[176:177], v48 offset:96
    ds_read_b64_tr_b16 v[178:179], v48 offset:1120
    ds_read_b64_tr_b16 v[180:181], v48 offset:8288
    ds_read_b64_tr_b16 v[182:183], v48 offset:9312
    ds_read_b64_tr_b16 v[184:185], v48 offset:16480
    ds_read_b64_tr_b16 v[186:187], v48 offset:17504
    ds_read_b64_tr_b16 v[188:189], v48 offset:24672
    ds_read_b64_tr_b16 v[190:191], v48 offset:25696
    s_waitcnt lgkmcnt(0)
    ds_read_b64_tr_b16 v[192:193], v48 offset:128
    ds_read_b64_tr_b16 v[194:195], v48 offset:1152
    ds_read_b64_tr_b16 v[196:197], v48 offset:8320
    ds_read_b64_tr_b16 v[198:199], v48 offset:9344
    ds_read_b64_tr_b16 v[200:201], v48 offset:16512
    ds_read_b64_tr_b16 v[202:203], v48 offset:17536
    ds_read_b64_tr_b16 v[204:205], v48 offset:24704
    ds_read_b64_tr_b16 v[206:207], v48 offset:25728
    s_waitcnt lgkmcnt(0)
    ds_read_b64_tr_b16 v[208:209], v48 offset:160
    ds_read_b64_tr_b16 v[210:211], v48 offset:1184
    ds_read_b64_tr_b16 v[212:213], v48 offset:8352
    ds_read_b64_tr_b16 v[214:215], v48 offset:9376
    ds_read_b64_tr_b16 v[216:217], v48 offset:16544
    ds_read_b64_tr_b16 v[218:219], v48 offset:17568
    ds_read_b64_tr_b16 v[220:221], v48 offset:24736
    ds_read_b64_tr_b16 v[222:223], v48 offset:25760
    s_waitcnt lgkmcnt(0)
    ds_read_b64_tr_b16 v[224:225], v48 offset:192
    ds_read_b64_tr_b16 v[226:227], v48 offset:1216
    ds_read_b64_tr_b16 v[228:229], v48 offset:8384
    ds_read_b64_tr_b16 v[230:231], v48 offset:9408
    ds_read_b64_tr_b16 v[232:233], v48 offset:16576
    ds_read_b64_tr_b16 v[234:235], v48 offset:17600
    ds_read_b64_tr_b16 v[236:237], v48 offset:24768
    ds_read_b64_tr_b16 v[238:239], v48 offset:25792
    s_waitcnt lgkmcnt(0)
    ds_read_b64_tr_b16 v[240:241], v48 offset:224
    ds_read_b64_tr_b16 v[242:243], v48 offset:1248
    ds_read_b64_tr_b16 v[244:245], v48 offset:8416
    ds_read_b64_tr_b16 v[246:247], v48 offset:9440
    ds_read_b64_tr_b16 v[248:249], v48 offset:16608
    ds_read_b64_tr_b16 v[250:251], v48 offset:17632
    ds_read_b64_tr_b16 v[252:253], v48 offset:24800
    ds_read_b64_tr_b16 v[254:255], v48 offset:25824
    s_waitcnt lgkmcnt(0)
    s_cmp_lg_u32 s66, 0
    s_cbranch_scc1 L_h_noml
    v_mov_b32 v48, 0
L_ml_poll:
    s_sleep 16
    ds_read_b128 v[52:55], v48 offset:26912
    s_waitcnt lgkmcnt(0)
    v_and_b32 v52, v52, v53
    v_and_b32 v54, v54, v55
    v_and_b32 v52, v52, v54
    v_cmp_eq_u32 vcc, 1, v52
    s_cbranch_vccz L_ml_poll
    ds_read_b128 v[52:55], v48 offset:26880
    ds_read_b128 v[56:59], v48 offset:26896
    s_waitcnt lgkmcnt(0)
    v_max_f32 v60, v52, v54
    v_max3_f32 v60, v60, v56, v58
    v_sub_f32 v64, v52, v60
    v_sub_f32 v65, v54, v60
    v_sub_f32 v66, v56, v60
    v_sub_f32 v67, v58, v60
    v_exp_f32 v64, v64
    v_exp_f32 v65, v65
    v_exp_f32 v66, v66
    v_exp_f32 v67, v67
    s_nop 0
    v_mul_f32 v61, v53, v64
    v_fmac_f32 v61, v55, v65
    v_fmac_f32 v61, v57, v66
    v_fmac_f32 v61, v59, v67
    s_lshl_b32 s68, s35, 5
    s_lshl_b32 s69, s34, 3
    s_add_u32 s69, s69, s68
    s_add_u32 s69, s69, 155648
    v_mov_b32 v68, s69
    s_lshr_b32 s70, s35, 3
    s_lshl_b32 s70, s70, 2
    s_add_u32 s70, s70, 32
    s_and_b32 s71, s35, 7
    s_lshl_b32 s71, s71, 2
    s_lshl_b32 s72, 1, s71
    v_mov_b32 v69, s70
    v_mov_b32 v70, s72
    s_mov_b64 exec, 1
    global_store_dwordx2 v68, v[60:61], s[30:31] sc0 sc1
    s_waitcnt vmcnt(0)
    global_atomic_add v69, v70, s[28:29]
    s_mov_b64 exec, -1
L_vp_poll:
    s_sleep 32
    ds_read_b32 v71, v48 offset:26960
    s_waitcnt lgkmcnt(0)
    v_cmp_gt_u32 vcc, 22, v71
    s_cbranch_vccnz L_vp_poll
L_grp_poll:
    global_load_dword v71, v69, s[28:29] sc0 sc1
    s_waitcnt vmcnt(0)
    v_lshrrev_b32 v73, s71, v71
    v_and_b32 v73, 7, v73
    v_and_b32 v71, 8, v71
    v_or_b32 v71, v71, v73
    v_cmp_eq_u32 vcc, 12, v71
    s_cbranch_vccnz L_grp_done
    s_sleep 64
    s_branch L_grp_poll
L_grp_done:
    v_and_b32 v72, 3, v0
    v_lshlrev_b32 v72, 3, v72
    s_add_u32 s68, s68, 155648
    v_add_u32 v72, s68, v72
    global_load_dwordx2 v[74:75], v72, s[30:31] sc0 sc1
    s_waitcnt vmcnt(0)
    v_max_f32_dpp v76, v74, v74 quad_perm:[1,0,3,2] row_mask:0xf bank_mask:0xf
    s_nop 1
    v_max_f32_dpp v76, v76, v76 quad_perm:[2,3,0,1] row_mask:0xf bank_mask:0xf
    s_nop 1
    v_sub_f32 v77, v74, v76
    v_exp_f32 v77, v77
    s_nop 0
    v_mul_f32 v77, v77, v75
    s_nop 1
    v_add_f32_dpp v77, v77, v77 quad_perm:[1,0,3,2] row_mask:0xf bank_mask:0xf
    s_nop 1
    v_add_f32_dpp v77, v77, v77 quad_perm:[2,3,0,1] row_mask:0xf bank_mask:0xf
    s_nop 1
    v_rcp_f32 v77, v77
    v_sub_f32 v64, v52, v76
    v_sub_f32 v65, v54, v76
    v_sub_f32 v66, v56, v76
    v_sub_f32 v67, v58, v76
    v_exp_f32 v64, v64
    v_exp_f32 v65, v65
    v_exp_f32 v66, v66
    v_exp_f32 v67, v67
    s_nop 0
    v_mul_f32 v64, v64, v77
    v_mul_f32 v65, v65, v77
    v_mul_f32 v66, v66, v77
    v_mul_f32 v67, v67, v77
    ds_write_b128 v48, v[64:67] offset:26944
    v_mov_b32 v78, 1
    s_waitcnt lgkmcnt(0)
    ds_write_b32 v48, v78 offset:26980
L_h_noml:
    s_and_b32 s72, s2, 7
    s_lshl_b32 s72, s72, 12
    s_lshl_b32 s73, s33, 11
    s_add_u32 s72, s72, s73
    s_lshl_b32 s73, s66, 9
    s_add_u32 s72, s72, s73
    v_lshrrev_b32 v88, 1, v3
    v_lshlrev_b32 v88, 6, v88
    v_lshl_add_u32 v88, v2, 2, v88
    v_add_u32 v88, s72, v88
    v_and_b32 v89, 7, v2
    v_lshlrev_b32 v89, 8, v89
    v_lshl_add_u32 v89, v3, 4, v89
    s_mov_b32 s74, 0
    s_mov_b32 s75, -1
    v_mov_b32 v90, 0
    s_waitcnt vmcnt(0) lgkmcnt(0)
    s_barrier
    ds_read_b128 v[16:19], v89 offset:28928
    ds_read_b128 v[20:23], v89 offset:28992
    ds_read_b128 v[24:27], v89 offset:29056
    ds_read_b128 v[28:31], v89 offset:29120
    s_waitcnt lgkmcnt(3)
    v_mfma_f32_16x16x32_bf16 v[48:51], v[16:19], v[128:131], 0
    v_mfma_f32_16x16x32_bf16 v[52:55], v[16:19], v[144:147], 0
    v_mfma_f32_16x16x32_bf16 v[56:59], v[16:19], v[160:163], 0
    v_mfma_f32_16x16x32_bf16 v[60:63], v[16:19], v[176:179], 0
    v_mfma_f32_16x16x32_bf16 v[64:67], v[16:19], v[192:195], 0
    v_mfma_f32_16x16x32_bf16 v[68:71], v[16:19], v[208:211], 0
    v_mfma_f32_16x16x32_bf16 v[72:75], v[16:19], v[224:227], 0
    v_mfma_f32_16x16x32_bf16 v[76:79], v[16:19], v[240:243], 0
    s_waitcnt lgkmcnt(2)
    v_mfma_f32_16x16x32_bf16 v[48:51], v[20:23], v[132:135], v[48:51]
    v_mfma_f32_16x16x32_bf16 v[52:55], v[20:23], v[148:151], v[52:55]
    v_mfma_f32_16x16x32_bf16 v[56:59], v[20:23], v[164:167], v[56:59]
    v_mfma_f32_16x16x32_bf16 v[60:63], v[20:23], v[180:183], v[60:63]
    v_mfma_f32_16x16x32_bf16 v[64:67], v[20:23], v[196:199], v[64:67]
    v_mfma_f32_16x16x32_bf16 v[68:71], v[20:23], v[212:215], v[68:71]
    v_mfma_f32_16x16x32_bf16 v[72:75], v[20:23], v[228:231], v[72:75]
    v_mfma_f32_16x16x32_bf16 v[76:79], v[20:23], v[244:247], v[76:79]
    s_waitcnt lgkmcnt(1)
    v_mfma_f32_16x16x32_bf16 v[48:51], v[24:27], v[136:139], v[48:51]
    v_mfma_f32_16x16x32_bf16 v[52:55], v[24:27], v[152:155], v[52:55]
    v_mfma_f32_16x16x32_bf16 v[56:59], v[24:27], v[168:171], v[56:59]
    v_mfma_f32_16x16x32_bf16 v[60:63], v[24:27], v[184:187], v[60:63]
    v_mfma_f32_16x16x32_bf16 v[64:67], v[24:27], v[200:203], v[64:67]
    v_mfma_f32_16x16x32_bf16 v[68:71], v[24:27], v[216:219], v[68:71]
    v_mfma_f32_16x16x32_bf16 v[72:75], v[24:27], v[232:235], v[72:75]
    v_mfma_f32_16x16x32_bf16 v[76:79], v[24:27], v[248:251], v[76:79]
    s_waitcnt lgkmcnt(0)
    v_mfma_f32_16x16x32_bf16 v[48:51], v[28:31], v[140:143], v[48:51]
    v_mfma_f32_16x16x32_bf16 v[52:55], v[28:31], v[156:159], v[52:55]
    v_mfma_f32_16x16x32_bf16 v[56:59], v[28:31], v[172:175], v[56:59]
    v_mfma_f32_16x16x32_bf16 v[60:63], v[28:31], v[188:191], v[60:63]
    v_mfma_f32_16x16x32_bf16 v[64:67], v[28:31], v[204:207], v[64:67]
    v_mfma_f32_16x16x32_bf16 v[68:71], v[28:31], v[220:223], v[68:71]
    v_mfma_f32_16x16x32_bf16 v[72:75], v[28:31], v[236:239], v[72:75]
    v_mfma_f32_16x16x32_bf16 v[76:79], v[28:31], v[252:255], v[76:79]
    s_nop 3
    v_add_f32 v48, v48, v49
    v_add_f32 v50, v50, v51
    v_add_f32 v52, v52, v53
    v_add_f32 v54, v54, v55
    v_add_f32 v56, v56, v57
    v_add_f32 v58, v58, v59
    v_add_f32 v60, v60, v61
    v_add_f32 v62, v62, v63
    v_add_f32 v64, v64, v65
    v_add_f32 v66, v66, v67
    v_add_f32 v68, v68, v69
    v_add_f32 v70, v70, v71
    v_add_f32 v72, v72, v73
    v_add_f32 v74, v74, v75
    v_add_f32 v76, v76, v77
    v_add_f32 v78, v78, v79
    v_add_f32 v48, v48, v50
    v_add_f32 v52, v52, v54
    v_add_f32 v56, v56, v58
    v_add_f32 v60, v60, v62
    v_add_f32 v64, v64, v66
    v_add_f32 v68, v68, v70
    v_add_f32 v72, v72, v74
    v_add_f32 v76, v76, v78
    v_cndmask_b32 v48, v48, v52, s[74:75]
    global_atomic_add_f32 v88, v48, s[30:31] offset:0
    v_cndmask_b32 v56, v56, v60, s[74:75]
    global_atomic_add_f32 v88, v56, s[30:31] offset:128
    v_cndmask_b32 v64, v64, v68, s[74:75]
    global_atomic_add_f32 v88, v64, s[30:31] offset:256
    v_cndmask_b32 v72, v72, v76, s[74:75]
    global_atomic_add_f32 v88, v72, s[30:31] offset:384
    s_waitcnt vmcnt(0)
    s_barrier
    s_cmp_lg_u32 s66, 0
    s_cbranch_scc1 L_h_noarr
    s_lshr_b32 s68, s2, 4
    s_lshl_b32 s68, s68, 8
    s_add_u32 s68, s68, 32768
    v_mov_b32 v48, s68
    v_mov_b32 v49, 1
    s_mov_b64 exec, 1
    global_atomic_add v48, v49, s[30:31]
    s_mov_b64 exec, -1
L_h_noarr:
    s_cmp_lg_u32 s2, 0
    s_cbranch_scc1 L_hend
    v_and_b32 v48, 15, v0
    v_lshlrev_b32 v48, 8, v48
    v_add_u32 v48, 32768, v48
    s_lshl_b32 s68, s66, 9
    v_lshlrev_b32 v49, 3, v0
    v_add_u32 v49, s68, v49
    global_load_dwordx2 v[52:53], v49, s[8:9]
    v_lshlrev_b32 v51, 1, v49
L_fin_poll:
    global_load_dword v50, v48, s[30:31] sc0 sc1
    s_waitcnt vmcnt(0)
    v_cmp_ne_u32 vcc, 16, v50
    s_cbranch_vccnz L_fin_poll
    global_load_dwordx4 v[128:131], v51, s[30:31] sc0 sc1
    v_add_u32 v51, 4096, v51
    global_load_dwordx4 v[132:135], v51, s[30:31] sc0 sc1
    v_add_u32 v51, 4096, v51
    global_load_dwordx4 v[136:139], v51, s[30:31] sc0 sc1
    v_add_u32 v51, 4096, v51
    global_load_dwordx4 v[140:143], v51, s[30:31] sc0 sc1
    v_add_u32 v51, 4096, v51
    global_load_dwordx4 v[144:147], v51, s[30:31] sc0 sc1
    v_add_u32 v51, 4096, v51
    global_load_dwordx4 v[148:151], v51, s[30:31] sc0 sc1
    v_add_u32 v51, 4096, v51
    global_load_dwordx4 v[152:155], v51, s[30:31] sc0 sc1
    v_add_u32 v51, 4096, v51
    global_load_dwordx4 v[156:159], v51, s[30:31] sc0 sc1
    v_add_u32 v51, 4096, v51
    v_lshlrev_b32 v56, 16, v52
    v_and_b32 v57, 0xffff0000, v52
    v_lshlrev_b32 v58, 16, v53
    v_and_b32 v59, 0xffff0000, v53
    s_waitcnt vmcnt(7)
    v_add_f32 v56, v56, v128
    v_add_f32 v57, v57, v129
    v_add_f32 v58, v58, v130
    v_add_f32 v59, v59, v131
    s_waitcnt vmcnt(6)
    v_add_f32 v56, v56, v132
    v_add_f32 v57, v57, v133
    v_add_f32 v58, v58, v134
    v_add_f32 v59, v59, v135
    s_waitcnt vmcnt(5)
    v_add_f32 v56, v56, v136
    v_add_f32 v57, v57, v137
    v_add_f32 v58, v58, v138
    v_add_f32 v59, v59, v139
    s_waitcnt vmcnt(4)
    v_add_f32 v56, v56, v140
    v_add_f32 v57, v57, v141
    v_add_f32 v58, v58, v142
    v_add_f32 v59, v59, v143
    s_waitcnt vmcnt(3)
    v_add_f32 v56, v56, v144
    v_add_f32 v57, v57, v145
    v_add_f32 v58, v58, v146
    v_add_f32 v59, v59, v147
    s_waitcnt vmcnt(2)
    v_add_f32 v56, v56, v148
    v_add_f32 v57, v57, v149
    v_add_f32 v58, v58, v150
    v_add_f32 v59, v59, v151
    s_waitcnt vmcnt(1)
    v_add_f32 v56, v56, v152
    v_add_f32 v57, v57, v153
    v_add_f32 v58, v58, v154
    v_add_f32 v59, v59, v155
    s_waitcnt vmcnt(0)
    v_add_f32 v56, v56, v156
    v_add_f32 v57, v57, v157
    v_add_f32 v58, v58, v158
    v_add_f32 v59, v59, v159
    v_cvt_pk_bf16_f32 v60, v56, v57
    v_cvt_pk_bf16_f32 v61, v58, v59
    global_store_dwordx2 v49, v[60:61], s[26:27]
L_hend:
L_end:
    s_endpgm
.section .rodata,"a"
.p2align 6
.amdhsa_kernel parallel_sum__mha_block_cached__glu_gated_swiglu__decode_kernel
  .amdhsa_next_free_vgpr 256
  .amdhsa_next_free_sgpr 102
  .amdhsa_accum_offset 256
  .amdhsa_group_segment_fixed_size 0
  .amdhsa_kernarg_size 96
  .amdhsa_user_sgpr_count 2
  .amdhsa_user_sgpr_kernarg_segment_ptr 1
  .amdhsa_system_sgpr_workgroup_id_x 1
.end_amdhsa_kernel
```
